```python
import torch

def _softmax(x, axis=-1):
    return torch.softmax(x, dim=axis)
def _gelu(x):
    return torch.nn.functional.gelu(x, approximate="tanh")
def _silu(x):
    return torch.nn.functional.silu(x)
def _sigmoid(x):
    return torch.sigmoid(x)
def _layernorm(x, axis=-1, eps=1e-5):
    m = x.mean(dim=axis, keepdim=True)
    v = x.var(dim=axis, keepdim=True, unbiased=False)
    return (x - m) / torch.sqrt(v + eps)
def _scatter_add(tgt, idx, src, axis=0):
    return tgt.clone().index_add_(axis, idx, src)
def _segment_sum(src, seg, n):
    out = torch.zeros((n,) + src.shape[1:], dtype=src.dtype)
    return out.index_add_(0, seg, src)
def _pad(x, pw):
    flat = tuple(v for pair in reversed(pw) for v in pair)
    return torch.nn.functional.pad(x, flat)

kernel_name = 'standalone__dcn_v2_cross__recsys'

def setup_inputs():

    _w = (lambda a: (lambda t: t.to(torch.bfloat16) if t.is_floating_point() else t)(torch.as_tensor(a)))
    B, F, D, L = 4096, 100, 32, 3
    Din = min(F * D, 1024)
    return {
        "x0": _w((lambda *s: torch.randn(*s, dtype=torch.bfloat16) * 0.05)(B, Din)),
        "ws": _w((lambda *s: torch.randn(*s, dtype=torch.bfloat16) * 0.05)(L, Din, Din)),
        "bs": _w((lambda *s: torch.randn(*s, dtype=torch.bfloat16) * 0.05)(L, Din)),
    }

def reference(x0, ws, bs):
    x = x0
    for l in range(ws.shape[0]):
        x = x0 * (x @ ws[l] + bs[l]) + x
    return x
```

```asm
; @launch grid=(256,1,1) block=(256,1,1) lds=149504
.amdgcn_target "amdgcn-amd-amdhsa--gfx950"
.text
.globl standalone__dcn_v2_cross__recsys_kernel
.p2align 8
.type standalone__dcn_v2_cross__recsys_kernel,@function
standalone__dcn_v2_cross__recsys_kernel:
    s_cmp_ge_u32 s2, 256
    s_cbranch_scc1 L_end
    s_load_dwordx4 s[40:43], s[0:1], 0
    s_load_dwordx4 s[44:47], s[0:1], 16
    s_load_dwordx4 s[48:51], s[0:1], 32
    s_getreg_b32 s37, hwreg(HW_REG_XCC_ID)
    v_lshrrev_b32 v20, 6, v0
    v_and_b32 v1, 63, v0
    v_readfirstlane_b32 s32, v20
    s_and_b32 s37, s37, 7
    s_lshr_b32 s75, s2, 3
    s_and_b32 s33, s75, 7
    s_lshr_b32 s75, s75, 3
    s_and_b32 s76, s2, 7
    s_lshl_b32 s76, s76, 2
    s_add_u32 s34, s76, s75
    s_mov_b32 s79, 0xffff0000
    s_mov_b32 s36, 0
    v_lshlrev_b32 v2, 4, v1
    v_lshrrev_b32 v20, 3, v1
    v_lshlrev_b32 v21, 11, v20
    v_and_b32 v22, 7, v1
    v_lshrrev_b32 v23, 4, v1
    v_and_b32 v23, 1, v23
    v_lshlrev_b32 v23, 2, v23
    v_xor_b32 v23, v22, v23
    v_lshlrev_b32 v23, 4, v23
    v_add_u32 v4, v21, v23
    v_add_u32 v5, 15360, v4
    v_add_u32 v6, 30720, v4
    v_add_u32 v7, 46080, v4
    v_lshrrev_b32 v24, 4, v1
    v_xor_b32 v25, v22, v24
    v_lshlrev_b32 v25, 4, v25
    v_add_u32 v230, v21, v25
    v_xor_b32 v231, 64, v230
    v_and_b32 v26, 31, v1
    v_lshrrev_b32 v27, 5, v1
    v_lshlrev_b32 v232, 7, v26
    v_lshrrev_b32 v25, 1, v26
    v_and_b32 v25, 7, v25
    v_lshlrev_b32 v25, 4, v25
    v_add_u32 v232, v232, v25
    v_lshlrev_b32 v25, 3, v27
    v_add_u32 v232, v232, v25
    s_lshl_b32 s75, s32, 12
    v_add_u32 v232, s75, v232
    v_add_u32 v233, 0x10000, v232
    v_and_b32 v20, 15, v1
    v_lshrrev_b32 v21, 2, v20
    v_lshlrev_b32 v22, 2, v27
    v_add_u32 v22, v22, v21
    v_lshlrev_b32 v22, 7, v22
    v_lshrrev_b32 v23, 4, v1
    v_and_b32 v23, 1, v23
    v_lshlrev_b32 v23, 5, v23
    v_and_b32 v25, 3, v20
    v_lshlrev_b32 v25, 3, v25
    v_add_u32 v23, v23, v25
    v_lshrrev_b32 v25, 1, v21
    v_and_b32 v25, 1, v25
    v_lshlrev_b32 v25, 6, v25
    v_xor_b32 v23, v23, v25
    v_add_u32 v8, v22, v23
    v_xor_b32 v9, 64, v8
    v_add_u32 v10, 0x10000, v8
    v_add_u32 v11, 0x10000, v9
    v_lshlrev_b32 v12, 4, v27
    v_add_u32 v12, 131072, v12
    s_lshl_b32 s75, s34, 7
    s_lshl_b32 s76, s32, 5
    s_add_u32 s75, s75, s76
    v_lshrrev_b32 v20, 3, v1
    v_and_b32 v21, 7, v1
    v_lshlrev_b32 v13, 11, v20
    v_lshlrev_b32 v22, 4, v21
    v_add_u32 v13, v13, v22
    s_lshl_b32 s78, s75, 11
    s_lshl_b32 s76, s33, 8
    s_add_u32 s88, s78, s76
    s_add_u32 s89, s88, 16384
    s_add_u32 s90, s88, 32768
    s_add_u32 s91, s88, 49152
    s_lshl_b32 s76, s32, 12
    s_add_u32 s76, s76, 133120
    v_xor_b32 v22, v20, v21
    v_lshlrev_b32 v22, 4, v22
    v_lshlrev_b32 v23, 7, v20
    v_add_u32 v240, v22, v23
    v_add_u32 v240, s76, v240
    v_mov_b32 v241, v240
    v_and_b32 v22, 7, v26
    v_xor_b32 v22, v22, v27
    v_lshlrev_b32 v22, 4, v22
    v_lshlrev_b32 v23, 7, v26
    v_add_u32 v234, v22, v23
    v_add_u32 v234, s76, v234
    s_lshl_b32 s81, s33, 8
    s_lshl_b32 s38, s75, 11
    s_lshl_b32 s76, s34, 2
    s_add_u32 s76, s76, s32
    s_lshl_b32 s76, s76, 7
    s_add_u32 s82, s76, 25165824
    s_mov_b32 s73, s82
    v_and_b32 v14, 7, v1
    v_lshlrev_b32 v14, 2, v14
    s_lshl_b32 s76, s33, 2
    v_mov_b32 v25, s76
    v_mov_b32 v15, 0x7fffff00
    v_mov_b32 v226, 0x7fffff00
    v_cmp_eq_u32 vcc, 0, v1
    s_lshr_b32 s76, s34, 4
    s_lshl_b32 s76, s76, 7
    s_and_b32 s78, s34, 15
    s_lshl_b32 s78, s78, 3
    s_add_u32 s76, s76, s78
    v_mov_b32 v225, s76
    v_cndmask_b32 v15, v15, v25, vcc
    v_cmp_eq_u32 vcc, 0, v0
    s_lshl_b32 s76, s37, 2
    s_lshl_b32 s76, 1, s76
    v_mov_b32 v229, s76
    v_cndmask_b32 v226, v226, v225, vcc
    v_mov_b32 v227, 0
    s_lshr_b32 s77, s2, 6
    s_mul_i32 s77, s77, 0
    s_lshl_b32 s75, s34, 2
    s_add_u32 s75, s75, s32
    s_lshl_b32 s75, s75, 16
    s_mov_b32 s78, s33
    s_lshl_b32 s78, s78, 13
    s_add_u32 s60, s78, s75
    s_add_u32 s78, s77, 0
    s_sub_u32 s76, s78, 7
    s_cmp_ge_u32 s78, 7
    s_cselect_b32 s78, s76, s78
    s_add_u32 s78, s78, s33
    s_add_u32 s78, s78, 1
    s_and_b32 s78, s78, 7
    s_lshl_b32 s78, s78, 13
    s_add_u32 s61, s78, s75
    s_add_u32 s78, s77, 1
    s_sub_u32 s76, s78, 7
    s_cmp_ge_u32 s78, 7
    s_cselect_b32 s78, s76, s78
    s_add_u32 s78, s78, s33
    s_add_u32 s78, s78, 1
    s_and_b32 s78, s78, 7
    s_lshl_b32 s78, s78, 13
    s_add_u32 s62, s78, s75
    s_add_u32 s78, s77, 2
    s_sub_u32 s76, s78, 7
    s_cmp_ge_u32 s78, 7
    s_cselect_b32 s78, s76, s78
    s_add_u32 s78, s78, s33
    s_add_u32 s78, s78, 1
    s_and_b32 s78, s78, 7
    s_lshl_b32 s78, s78, 13
    s_add_u32 s63, s78, s75
    s_add_u32 s78, s77, 3
    s_sub_u32 s76, s78, 7
    s_cmp_ge_u32 s78, 7
    s_cselect_b32 s78, s76, s78
    s_add_u32 s78, s78, s33
    s_add_u32 s78, s78, 1
    s_and_b32 s78, s78, 7
    s_lshl_b32 s78, s78, 13
    s_add_u32 s64, s78, s75
    s_add_u32 s78, s77, 4
    s_sub_u32 s76, s78, 7
    s_cmp_ge_u32 s78, 7
    s_cselect_b32 s78, s76, s78
    s_add_u32 s78, s78, s33
    s_add_u32 s78, s78, 1
    s_and_b32 s78, s78, 7
    s_lshl_b32 s78, s78, 13
    s_add_u32 s65, s78, s75
    s_add_u32 s78, s77, 5
    s_sub_u32 s76, s78, 7
    s_cmp_ge_u32 s78, 7
    s_cselect_b32 s78, s76, s78
    s_add_u32 s78, s78, s33
    s_add_u32 s78, s78, 1
    s_and_b32 s78, s78, 7
    s_lshl_b32 s78, s78, 13
    s_add_u32 s66, s78, s75
    s_add_u32 s78, s77, 6
    s_sub_u32 s76, s78, 7
    s_cmp_ge_u32 s78, 7
    s_cselect_b32 s78, s76, s78
    s_add_u32 s78, s78, s33
    s_add_u32 s78, s78, 1
    s_and_b32 s78, s78, 7
    s_lshl_b32 s78, s78, 13
    s_add_u32 s67, s78, s75
    s_and_b32 s76, s32, 1
    s_lshl_b32 s76, s76, 16
    s_cmp_ge_u32 s32, 2
    s_cselect_b32 s78, s61, s60
    s_and_b32 s78, s78, 0xe000
    s_lshl_b32 s78, s78, 5
    s_add_u32 s52, s78, s76
    s_add_u32 s56, s52, 131072
    s_cmp_ge_u32 s32, 2
    s_cselect_b32 s78, s63, s62
    s_and_b32 s78, s78, 0xe000
    s_lshl_b32 s78, s78, 5
    s_add_u32 s53, s78, s76
    s_add_u32 s57, s53, 131072
    s_cmp_ge_u32 s32, 2
    s_cselect_b32 s78, s65, s64
    s_and_b32 s78, s78, 0xe000
    s_lshl_b32 s78, s78, 5
    s_add_u32 s54, s78, s76
    s_add_u32 s58, s54, 131072
    s_cmp_ge_u32 s32, 2
    s_cselect_b32 s78, s67, s66
    s_and_b32 s78, s78, 0xe000
    s_lshl_b32 s78, s78, 5
    s_add_u32 s55, s78, s76
    s_add_u32 s59, s55, 131072
    v_lshlrev_b32 v243, 11, v1
    s_lshr_b32 s93, s2, 6
    s_lshl_b32 s93, s93, 2
    s_add_u32 s93, s93, s32
    s_lshl_b32 s93, s93, 17
    s_lshl_b32 s70, s32, 12
    s_lshl_b32 s68, s33, 8
    s_add_u32 s69, s68, 128
    s_mov_b32 s35, 0
    s_mov_b32 s87, 0
    s_waitcnt lgkmcnt(0)
    s_mov_b32 s12, s40
    s_and_b32 s13, s41, 0xffff
    s_mov_b32 s14, 8388608
    s_mov_b32 s15, 0x00020000
    s_mov_b32 s8, s42
    s_and_b32 s9, s43, 0xffff
    s_mov_b32 s10, 6291456
    s_mov_b32 s11, 0x00020000
    s_mov_b32 s24, s44
    s_and_b32 s25, s45, 0xffff
    s_mov_b32 s26, 6144
    s_mov_b32 s27, 0x00020000
    s_mov_b32 s20, s46
    s_and_b32 s21, s47, 0xffff
    s_mov_b32 s22, 8388608
    s_mov_b32 s23, 0x00020000
    s_mov_b32 s28, s48
    s_and_b32 s29, s49, 0xffff
    s_mov_b32 s30, 256
    s_mov_b32 s31, 0x00020000
    s_mov_b32 s16, s50
    s_and_b32 s17, s51, 0xffff
    s_mov_b32 s18, 33554432
    s_mov_b32 s19, 0x00020000
    s_getpc_b64 s[94:95]
CODE_PC:
    s_lshr_b32 s75, s2, 3
    s_lshl_b32 s75, s75, 2
    s_add_u32 s75, s75, s32
    s_lshl_b32 s75, s75, 8
    s_cmp_lt_u32 s75, CODE_END - CODE_PC - 256
    s_cselect_b32 s75, s75, 0
CODE_PC_NEXT:
    s_load_dword s96, s[94:95], s75
    s_add_u32 s75, s75, 128
    s_load_dword s97, s[94:95], s75
    s_and_b32 s74, s60, 0xe000
    s_lshr_b32 s74, s74, 5
    s_add_u32 s74, s74, s38
    s_add_u32 m0, s70, 49152
    s_nop 0
    buffer_load_dwordx4 v230, s[12:15], s74 offen lds
    s_add_u32 s74, s74, 16384
    s_add_u32 m0, s70, 50176
    s_nop 0
    buffer_load_dwordx4 v231, s[12:15], s74 offen lds
    s_add_u32 s74, s74, 16384
    s_add_u32 m0, s70, 51200
    s_nop 0
    buffer_load_dwordx4 v230, s[12:15], s74 offen lds
    s_add_u32 s74, s74, 16384
    s_add_u32 m0, s70, 52224
    s_nop 0
    buffer_load_dwordx4 v231, s[12:15], s74 offen lds
    s_add_u32 s83, s68, s52
    s_add_u32 m0, s70, 0
    s_nop 0
    buffer_load_dwordx4 v4, s[8:11], s83 offen lds
    buffer_load_dwordx4 v5, s[8:11], s83 offen offset:1024 lds
    buffer_load_dwordx4 v6, s[8:11], s83 offen offset:2048 lds
    buffer_load_dwordx4 v7, s[8:11], s83 offen offset:3072 lds
    v_lshrrev_b32 v20, 6, v0
    v_lshlrev_b32 v20, 11, v20
    v_lshlrev_b32 v21, 2, v1
    v_add_u32 v20, v20, v21
    buffer_load_dword v28, v20, s[24:27], s81 offen
    s_and_b32 s74, s61, 0xe000
    s_lshr_b32 s74, s74, 5
    s_add_u32 s74, s74, s38
    s_add_u32 m0, s70, 65536
    s_nop 0
    buffer_load_dwordx4 v230, s[12:15], s74 offen lds
    s_add_u32 s74, s74, 16384
    s_add_u32 m0, s70, 66560
    s_nop 0
    buffer_load_dwordx4 v231, s[12:15], s74 offen lds
    s_add_u32 s74, s74, 16384
    s_add_u32 m0, s70, 67584
    s_nop 0
    buffer_load_dwordx4 v230, s[12:15], s74 offen lds
    s_add_u32 s74, s74, 16384
    s_add_u32 m0, s70, 68608
    s_nop 0
    buffer_load_dwordx4 v231, s[12:15], s74 offen lds
    s_and_b32 s74, s62, 0xe000
    s_lshr_b32 s74, s74, 5
    s_add_u32 s74, s74, s38
    s_add_u32 m0, s70, 81920
    s_nop 0
    buffer_load_dwordx4 v230, s[12:15], s74 offen lds
    s_add_u32 s74, s74, 16384
    s_add_u32 m0, s70, 82944
    s_nop 0
    buffer_load_dwordx4 v231, s[12:15], s74 offen lds
    s_add_u32 s74, s74, 16384
    s_add_u32 m0, s70, 83968
    s_nop 0
    buffer_load_dwordx4 v230, s[12:15], s74 offen lds
    s_add_u32 s74, s74, 16384
    s_add_u32 m0, s70, 84992
    s_nop 0
    buffer_load_dwordx4 v231, s[12:15], s74 offen lds
    s_add_u32 s83, s68, s53
    s_add_u32 m0, s70, 16384
    s_nop 0
    buffer_load_dwordx4 v4, s[8:11], s83 offen lds
    buffer_load_dwordx4 v5, s[8:11], s83 offen offset:1024 lds
    buffer_load_dwordx4 v6, s[8:11], s83 offen offset:2048 lds
    buffer_load_dwordx4 v7, s[8:11], s83 offen offset:3072 lds
    s_and_b32 s74, s63, 0xe000
    s_lshr_b32 s74, s74, 5
    s_add_u32 s74, s74, s38
    s_add_u32 m0, s70, 98304
    s_nop 0
    buffer_load_dwordx4 v230, s[12:15], s74 offen lds
    s_add_u32 s74, s74, 16384
    s_add_u32 m0, s70, 99328
    s_nop 0
    buffer_load_dwordx4 v231, s[12:15], s74 offen lds
    s_add_u32 s74, s74, 16384
    s_add_u32 m0, s70, 100352
    s_nop 0
    buffer_load_dwordx4 v230, s[12:15], s74 offen lds
    s_add_u32 s74, s74, 16384
    s_add_u32 m0, s70, 101376
    s_nop 0
    buffer_load_dwordx4 v231, s[12:15], s74 offen lds
    s_and_b32 s74, s64, 0xe000
    s_lshr_b32 s74, s74, 5
    s_add_u32 s74, s74, s38
    s_add_u32 m0, s70, 114688
    s_nop 0
    buffer_load_dwordx4 v230, s[12:15], s74 offen lds
    s_add_u32 s74, s74, 16384
    s_add_u32 m0, s70, 115712
    s_nop 0
    buffer_load_dwordx4 v231, s[12:15], s74 offen lds
    s_add_u32 s74, s74, 16384
    s_add_u32 m0, s70, 116736
    s_nop 0
    buffer_load_dwordx4 v230, s[12:15], s74 offen lds
    s_add_u32 s74, s74, 16384
    s_add_u32 m0, s70, 117760
    s_nop 0
    buffer_load_dwordx4 v231, s[12:15], s74 offen lds
    s_add_u32 s83, s68, s54
    s_add_u32 m0, s70, 32768
    s_nop 0
    buffer_load_dwordx4 v4, s[8:11], s83 offen lds
    buffer_load_dwordx4 v5, s[8:11], s83 offen offset:1024 lds
    buffer_load_dwordx4 v6, s[8:11], s83 offen offset:2048 lds
    buffer_load_dwordx4 v7, s[8:11], s83 offen offset:3072 lds
    buffer_store_dword v227, v15, s[16:19], s82 offen sc1
    s_waitcnt vmcnt(25)
    v_lshlrev_b32 v30, 16, v28
    v_and_b32 v31, s79, v28
    v_lshlrev_b32 v29, 3, v0
    v_add_u32 v29, 131072, v29
    ds_write_b64 v29, v[30:31]
    s_waitcnt vmcnt(30)
    ds_read_b64 v[128:129], v232 offset:49152
    v_xor_b32 v193, 16, v232
    ds_read_b64 v[130:131], v193 offset:49152
    v_xor_b32 v194, 32, v232
    ds_read_b64 v[132:133], v194 offset:49152
    v_xor_b32 v195, 48, v232
    ds_read_b64 v[134:135], v195 offset:49152
    v_xor_b32 v196, 64, v232
    ds_read_b64 v[136:137], v196 offset:49152
    v_xor_b32 v197, 80, v232
    ds_read_b64 v[138:139], v197 offset:49152
    v_xor_b32 v198, 96, v232
    ds_read_b64 v[140:141], v198 offset:49152
    v_xor_b32 v199, 112, v232
    ds_read_b64 v[142:143], v199 offset:49152
    s_waitcnt vmcnt(21)
    ds_read_b64 a[0:1], v233 offset:0
    v_xor_b32 v193, 16, v233
    ds_read_b64 a[2:3], v193 offset:0
    v_xor_b32 v194, 32, v233
    ds_read_b64 a[4:5], v194 offset:0
    v_xor_b32 v195, 48, v233
    ds_read_b64 a[6:7], v195 offset:0
    v_xor_b32 v196, 64, v233
    ds_read_b64 a[8:9], v196 offset:0
    v_xor_b32 v197, 80, v233
    ds_read_b64 a[10:11], v197 offset:0
    v_xor_b32 v198, 96, v233
    ds_read_b64 a[12:13], v198 offset:0
    v_xor_b32 v199, 112, v233
    ds_read_b64 a[14:15], v199 offset:0
    s_waitcnt lgkmcnt(0)
    v_mov_b32 v160, v128
    v_mov_b32 v161, v129
    v_mov_b32 v162, v130
    v_mov_b32 v163, v131
    v_mov_b32 v164, v132
    v_mov_b32 v165, v133
    v_mov_b32 v166, v134
    v_mov_b32 v167, v135
    v_mov_b32 v168, v136
    v_mov_b32 v169, v137
    v_mov_b32 v170, v138
    v_mov_b32 v171, v139
    v_mov_b32 v172, v140
    v_mov_b32 v173, v141
    v_mov_b32 v174, v142
    v_mov_b32 v175, v143
    s_waitcnt vmcnt(26)
    s_barrier
    ds_read_b128 v[32:35], v12 offset:0
    ds_read_b128 v[36:39], v12 offset:32
    ds_read_b128 v[40:43], v12 offset:64
    ds_read_b128 v[44:47], v12 offset:96
    ds_read_b128 v[48:51], v12 offset:128
    ds_read_b128 v[52:55], v12 offset:160
    ds_read_b128 v[56:59], v12 offset:192
    ds_read_b128 v[60:63], v12 offset:224
    ds_read_b64_tr_b16 v[96:97], v8 offset:0
    ds_read_b64_tr_b16 v[98:99], v8 offset:1024
    ds_read_b64_tr_b16 v[100:101], v9 offset:0
    ds_read_b64_tr_b16 v[102:103], v9 offset:1024
    ds_read_b64_tr_b16 v[104:105], v8 offset:2048
    ds_read_b64_tr_b16 v[106:107], v8 offset:3072
    ds_read_b64_tr_b16 v[108:109], v9 offset:2048
    ds_read_b64_tr_b16 v[110:111], v9 offset:3072
    s_waitcnt lgkmcnt(4)
    v_mfma_f32_32x32x16_bf16 v[32:47], v[96:99], v[128:131], v[32:47]
    ds_read_b64_tr_b16 v[112:113], v8 offset:4096
    ds_read_b64_tr_b16 v[114:115], v8 offset:5120
    s_and_b32 s74, s65, 0xe000
    s_lshr_b32 s74, s74, 5
    s_add_u32 s74, s74, s38
    s_add_u32 m0, s70, 65536
    s_nop 0
    buffer_load_dwordx4 v230, s[12:15], s74 offen lds
    v_mfma_f32_32x32x16_bf16 v[48:63], v[100:103], v[128:131], v[48:63]
    ds_read_b64_tr_b16 v[116:117], v9 offset:4096
    ds_read_b64_tr_b16 v[118:119], v9 offset:5120
    s_waitcnt vmcnt(18)
    ds_read_b64 a[16:17], v233 offset:16384
    v_xor_b32 v193, 16, v233
    ds_read_b64 a[18:19], v193 offset:16384
    s_add_u32 s74, s74, 16384
    s_add_u32 m0, s70, 66560
    s_nop 0
    buffer_load_dwordx4 v231, s[12:15], s74 offen lds
    s_waitcnt lgkmcnt(4)
    v_mfma_f32_32x32x16_bf16 v[32:47], v[104:107], v[132:135], v[32:47]
    ds_read_b64_tr_b16 v[120:121], v8 offset:6144
    ds_read_b64_tr_b16 v[122:123], v8 offset:7168
    v_xor_b32 v194, 32, v233
    ds_read_b64 a[20:21], v194 offset:16384
    v_xor_b32 v195, 48, v233
    ds_read_b64 a[22:23], v195 offset:16384
    s_add_u32 s74, s74, 16384
    s_add_u32 m0, s70, 67584
    s_nop 0
    buffer_load_dwordx4 v230, s[12:15], s74 offen lds
    v_mfma_f32_32x32x16_bf16 v[48:63], v[108:111], v[132:135], v[48:63]
    ds_read_b64_tr_b16 v[124:125], v9 offset:6144
    ds_read_b64_tr_b16 v[126:127], v9 offset:7168
    s_add_u32 s83, s68, s55
    s_add_u32 m0, s70, 49152
    s_nop 0
    buffer_load_dwordx4 v4, s[8:11], s83 offen lds
    v_xor_b32 v196, 64, v233
    ds_read_b64 a[24:25], v196 offset:16384
    v_xor_b32 v197, 80, v233
    ds_read_b64 a[26:27], v197 offset:16384
    s_waitcnt lgkmcnt(4)
    v_mfma_f32_32x32x16_bf16 v[32:47], v[112:115], v[136:139], v[32:47]
    ds_read_b64_tr_b16 v[96:97], v8 offset:8192
    ds_read_b64_tr_b16 v[98:99], v8 offset:9216
    v_xor_b32 v198, 96, v233
    ds_read_b64 a[28:29], v198 offset:16384
    v_xor_b32 v199, 112, v233
    ds_read_b64 a[30:31], v199 offset:16384
    s_add_u32 s74, s74, 16384
    s_add_u32 m0, s70, 68608
    s_nop 0
    buffer_load_dwordx4 v231, s[12:15], s74 offen lds
    v_mfma_f32_32x32x16_bf16 v[48:63], v[116:119], v[136:139], v[48:63]
    ds_read_b64_tr_b16 v[100:101], v9 offset:8192
    ds_read_b64_tr_b16 v[102:103], v9 offset:9216
    s_waitcnt vmcnt(14)
    ds_read_b64 a[32:33], v233 offset:32768
    v_xor_b32 v193, 16, v233
    ds_read_b64 a[34:35], v193 offset:32768
    s_waitcnt lgkmcnt(4)
    v_mfma_f32_32x32x16_bf16 v[32:47], v[120:123], v[140:143], v[32:47]
    ds_read_b64_tr_b16 v[104:105], v8 offset:10240
    ds_read_b64_tr_b16 v[106:107], v8 offset:11264
    v_xor_b32 v194, 32, v233
    ds_read_b64 a[36:37], v194 offset:32768
    v_xor_b32 v195, 48, v233
    ds_read_b64 a[38:39], v195 offset:32768
    s_and_b32 s74, s66, 0xe000
    s_lshr_b32 s74, s74, 5
    s_add_u32 s74, s74, s38
    s_add_u32 m0, s70, 81920
    s_nop 0
    buffer_load_dwordx4 v230, s[12:15], s74 offen lds
    v_mfma_f32_32x32x16_bf16 v[48:63], v[124:127], v[140:143], v[48:63]
    ds_read_b64_tr_b16 v[108:109], v9 offset:10240
    ds_read_b64_tr_b16 v[110:111], v9 offset:11264
    s_add_u32 m0, s70, 49152
    s_nop 0
    buffer_load_dwordx4 v5, s[8:11], s83 offen offset:1024 lds
    v_xor_b32 v196, 64, v233
    ds_read_b64 a[40:41], v196 offset:32768
    v_xor_b32 v197, 80, v233
    ds_read_b64 a[42:43], v197 offset:32768
    s_waitcnt lgkmcnt(4)
    v_mfma_f32_32x32x16_bf16 v[32:47], v[96:99], a[0:3], v[32:47]
    ds_read_b64_tr_b16 v[112:113], v8 offset:12288
    ds_read_b64_tr_b16 v[114:115], v8 offset:13312
    v_xor_b32 v198, 96, v233
    ds_read_b64 a[44:45], v198 offset:32768
    v_xor_b32 v199, 112, v233
    ds_read_b64 a[46:47], v199 offset:32768
    s_add_u32 s74, s74, 16384
    s_add_u32 m0, s70, 82944
    s_nop 0
    buffer_load_dwordx4 v231, s[12:15], s74 offen lds
    v_mfma_f32_32x32x16_bf16 v[48:63], v[100:103], a[0:3], v[48:63]
    ds_read_b64_tr_b16 v[116:117], v9 offset:12288
    ds_read_b64_tr_b16 v[118:119], v9 offset:13312
    s_waitcnt vmcnt(13)
    ds_read_b64 a[48:49], v233 offset:49152
    v_xor_b32 v193, 16, v233
    ds_read_b64 a[50:51], v193 offset:49152
    s_add_u32 s74, s74, 16384
    s_add_u32 m0, s70, 83968
    s_nop 0
    buffer_load_dwordx4 v230, s[12:15], s74 offen lds
    s_waitcnt lgkmcnt(4)
    v_mfma_f32_32x32x16_bf16 v[32:47], v[104:107], a[4:7], v[32:47]
    ds_read_b64_tr_b16 v[120:121], v8 offset:14336
    ds_read_b64_tr_b16 v[122:123], v8 offset:15360
    v_xor_b32 v194, 32, v233
    ds_read_b64 a[52:53], v194 offset:49152
    v_xor_b32 v195, 48, v233
    ds_read_b64 a[54:55], v195 offset:49152
    s_add_u32 s74, s74, 16384
    s_add_u32 m0, s70, 84992
    s_nop 0
    buffer_load_dwordx4 v231, s[12:15], s74 offen lds
    v_mfma_f32_32x32x16_bf16 v[48:63], v[108:111], a[4:7], v[48:63]
    ds_read_b64_tr_b16 v[124:125], v9 offset:14336
    ds_read_b64_tr_b16 v[126:127], v9 offset:15360
    s_add_u32 m0, s70, 49152
    s_nop 0
    buffer_load_dwordx4 v6, s[8:11], s83 offen offset:2048 lds
    v_xor_b32 v196, 64, v233
    ds_read_b64 a[56:57], v196 offset:49152
    v_xor_b32 v197, 80, v233
    ds_read_b64 a[58:59], v197 offset:49152
    s_waitcnt vmcnt(24)
    s_barrier
    s_waitcnt lgkmcnt(4)
    v_mfma_f32_32x32x16_bf16 v[32:47], v[112:115], a[8:11], v[32:47]
    ds_read_b64_tr_b16 v[96:97], v8 offset:16384
    ds_read_b64_tr_b16 v[98:99], v8 offset:17408
    v_xor_b32 v198, 96, v233
    ds_read_b64 a[60:61], v198 offset:49152
    v_xor_b32 v199, 112, v233
    ds_read_b64 a[62:63], v199 offset:49152
    s_and_b32 s74, s67, 0xe000
    s_lshr_b32 s74, s74, 5
    s_add_u32 s74, s74, s38
    s_add_u32 m0, s70, 98304
    s_nop 0
    buffer_load_dwordx4 v230, s[12:15], s74 offen lds
    v_mfma_f32_32x32x16_bf16 v[48:63], v[116:119], a[8:11], v[48:63]
    ds_read_b64_tr_b16 v[100:101], v9 offset:16384
    ds_read_b64_tr_b16 v[102:103], v9 offset:17408
    s_add_u32 s74, s74, 16384
    s_add_u32 m0, s70, 99328
    s_nop 0
    buffer_load_dwordx4 v231, s[12:15], s74 offen lds
    s_waitcnt lgkmcnt(4)
    v_mfma_f32_32x32x16_bf16 v[32:47], v[120:123], a[12:15], v[32:47]
    ds_read_b64_tr_b16 v[104:105], v8 offset:18432
    ds_read_b64_tr_b16 v[106:107], v8 offset:19456
    s_waitcnt vmcnt(8)
    ds_read_b64 a[64:65], v233 offset:0
    v_xor_b32 v193, 16, v233
    ds_read_b64 a[66:67], v193 offset:0
    s_add_u32 s74, s74, 16384
    s_add_u32 m0, s70, 100352
    s_nop 0
    buffer_load_dwordx4 v230, s[12:15], s74 offen lds
    v_mfma_f32_32x32x16_bf16 v[48:63], v[124:127], a[12:15], v[48:63]
    ds_read_b64_tr_b16 v[108:109], v9 offset:18432
    ds_read_b64_tr_b16 v[110:111], v9 offset:19456
    s_add_u32 m0, s70, 49152
    s_nop 0
    buffer_load_dwordx4 v7, s[8:11], s83 offen offset:3072 lds
    v_xor_b32 v194, 32, v233
    ds_read_b64 a[68:69], v194 offset:0
    v_xor_b32 v195, 48, v233
    ds_read_b64 a[70:71], v195 offset:0
    s_waitcnt lgkmcnt(4)
    v_mfma_f32_32x32x16_bf16 v[32:47], v[96:99], a[16:19], v[32:47]
    ds_read_b64_tr_b16 v[112:113], v8 offset:20480
    ds_read_b64_tr_b16 v[114:115], v8 offset:21504
    v_xor_b32 v196, 64, v233
    ds_read_b64 a[72:73], v196 offset:0
    v_xor_b32 v197, 80, v233
    ds_read_b64 a[74:75], v197 offset:0
    s_add_u32 s74, s74, 16384
    s_add_u32 m0, s70, 101376
    s_nop 0
    buffer_load_dwordx4 v231, s[12:15], s74 offen lds
    v_mfma_f32_32x32x16_bf16 v[48:63], v[100:103], a[16:19], v[48:63]
    ds_read_b64_tr_b16 v[116:117], v9 offset:20480
    ds_read_b64_tr_b16 v[118:119], v9 offset:21504
    v_xor_b32 v198, 96, v233
    ds_read_b64 a[76:77], v198 offset:0
    v_xor_b32 v199, 112, v233
    ds_read_b64 a[78:79], v199 offset:0
    s_and_b32 s74, s60, 0xe000
    s_lshr_b32 s74, s74, 5
    s_add_u32 s74, s74, s38
    s_add_u32 s74, s74, 128
    s_add_u32 m0, s70, 114688
    s_nop 0
    buffer_load_dwordx4 v230, s[12:15], s74 offen lds
    s_waitcnt lgkmcnt(4)
    v_mfma_f32_32x32x16_bf16 v[32:47], v[104:107], a[20:23], v[32:47]
    ds_read_b64_tr_b16 v[120:121], v8 offset:22528
    ds_read_b64_tr_b16 v[122:123], v8 offset:23552
    s_add_u32 s74, s74, 16384
    s_add_u32 m0, s70, 115712
    s_nop 0
    buffer_load_dwordx4 v231, s[12:15], s74 offen lds
    v_mfma_f32_32x32x16_bf16 v[48:63], v[108:111], a[20:23], v[48:63]
    ds_read_b64_tr_b16 v[124:125], v9 offset:22528
    ds_read_b64_tr_b16 v[126:127], v9 offset:23552
    s_add_u32 s83, s68, s56
    s_add_u32 m0, s70, 65536
    s_nop 0
    buffer_load_dwordx4 v4, s[8:11], s83 offen lds
    s_waitcnt lgkmcnt(4)
    v_mfma_f32_32x32x16_bf16 v[32:47], v[112:115], a[24:27], v[32:47]
    ds_read_b64_tr_b16 v[96:97], v8 offset:24576
    ds_read_b64_tr_b16 v[98:99], v8 offset:25600
    s_add_u32 s74, s74, 16384
    s_add_u32 m0, s70, 116736
    s_nop 0
    buffer_load_dwordx4 v230, s[12:15], s74 offen lds
    v_mfma_f32_32x32x16_bf16 v[48:63], v[116:119], a[24:27], v[48:63]
    ds_read_b64_tr_b16 v[100:101], v9 offset:24576
    ds_read_b64_tr_b16 v[102:103], v9 offset:25600
    s_add_u32 s74, s74, 16384
    s_add_u32 m0, s70, 117760
    s_nop 0
    buffer_load_dwordx4 v231, s[12:15], s74 offen lds
    s_waitcnt lgkmcnt(4)
    v_mfma_f32_32x32x16_bf16 v[32:47], v[120:123], a[28:31], v[32:47]
    ds_read_b64_tr_b16 v[104:105], v8 offset:26624
    ds_read_b64_tr_b16 v[106:107], v8 offset:27648
    s_mul_i32 s39, s2, 24576
    s_mul_i32 s76, s32, 6144
    s_add_u32 s39, s39, s76
    buffer_load_dwordx4 v[236:239], v2, s[8:11], s39 offen offset:0
    v_mfma_f32_32x32x16_bf16 v[48:63], v[124:127], a[28:31], v[48:63]
    ds_read_b64_tr_b16 v[108:109], v9 offset:26624
    ds_read_b64_tr_b16 v[110:111], v9 offset:27648
    s_add_u32 m0, s70, 65536
    s_nop 0
    buffer_load_dwordx4 v5, s[8:11], s83 offen offset:1024 lds
    s_waitcnt lgkmcnt(4)
    v_mfma_f32_32x32x16_bf16 v[32:47], v[96:99], a[32:35], v[32:47]
    ds_read_b64_tr_b16 v[112:113], v8 offset:28672
    ds_read_b64_tr_b16 v[114:115], v8 offset:29696
    buffer_load_dwordx4 v[236:239], v2, s[8:11], s39 offen offset:1024
    v_mfma_f32_32x32x16_bf16 v[48:63], v[100:103], a[32:35], v[48:63]
    ds_read_b64_tr_b16 v[116:117], v9 offset:28672
    ds_read_b64_tr_b16 v[118:119], v9 offset:29696
    buffer_load_dwordx4 v[236:239], v2, s[8:11], s39 offen offset:2048
    s_waitcnt lgkmcnt(4)
    v_mfma_f32_32x32x16_bf16 v[32:47], v[104:107], a[36:39], v[32:47]
    ds_read_b64_tr_b16 v[120:121], v8 offset:30720
    ds_read_b64_tr_b16 v[122:123], v8 offset:31744
    s_waitcnt vmcnt(15)
    ds_read_b64 a[80:81], v233 offset:16384
    v_xor_b32 v193, 16, v233
    ds_read_b64 a[82:83], v193 offset:16384
    buffer_load_dwordx4 v[236:239], v2, s[8:11], s39 offen offset:3072
    v_mfma_f32_32x32x16_bf16 v[48:63], v[108:111], a[36:39], v[48:63]
    ds_read_b64_tr_b16 v[124:125], v9 offset:30720
    ds_read_b64_tr_b16 v[126:127], v9 offset:31744
    s_add_u32 m0, s70, 65536
    s_nop 0
    buffer_load_dwordx4 v6, s[8:11], s83 offen offset:2048 lds
    s_waitcnt vmcnt(27)
    v_xor_b32 v194, 32, v233
    ds_read_b64 a[84:85], v194 offset:16384
    v_xor_b32 v195, 48, v233
    ds_read_b64 a[86:87], v195 offset:16384
    s_waitcnt vmcnt(28)
    s_barrier
    s_waitcnt lgkmcnt(4)
    v_mfma_f32_32x32x16_bf16 v[32:47], v[112:115], a[40:43], v[32:47]
    ds_read_b64_tr_b16 v[96:97], v8 offset:32768
    ds_read_b64_tr_b16 v[98:99], v8 offset:33792
    v_xor_b32 v196, 64, v233
    ds_read_b64 a[88:89], v196 offset:16384
    v_xor_b32 v197, 80, v233
    ds_read_b64 a[90:91], v197 offset:16384
    s_waitcnt vmcnt(11)
    ds_read_b64 a[96:97], v233 offset:32768
    v_xor_b32 v193, 16, v233
    ds_read_b64 a[98:99], v193 offset:32768
    s_add_u32 s39, s39, 4096
    buffer_load_dwordx4 v[236:239], v2, s[8:11], s39 offen offset:0
    v_mfma_f32_32x32x16_bf16 v[48:63], v[116:119], a[40:43], v[48:63]
    ds_read_b64_tr_b16 v[100:101], v9 offset:32768
    ds_read_b64_tr_b16 v[102:103], v9 offset:33792
    v_xor_b32 v198, 96, v233
    ds_read_b64 a[92:93], v198 offset:16384
    v_xor_b32 v199, 112, v233
    ds_read_b64 a[94:95], v199 offset:16384
    v_xor_b32 v194, 32, v233
    ds_read_b64 a[100:101], v194 offset:32768
    v_xor_b32 v195, 48, v233
    ds_read_b64 a[102:103], v195 offset:32768
    s_and_b32 s74, s63, 0xe000
    s_lshr_b32 s74, s74, 5
    s_add_u32 s74, s74, s38
    s_add_u32 s74, s74, 128
    s_add_u32 m0, s70, 0
    s_nop 0
    buffer_load_dwordx4 v230, s[12:15], s74 offen lds
    s_waitcnt lgkmcnt(4)
    v_mfma_f32_32x32x16_bf16 v[32:47], v[120:123], a[44:47], v[32:47]
    ds_read_b64_tr_b16 v[104:105], v8 offset:34816
    ds_read_b64_tr_b16 v[106:107], v8 offset:35840
    buffer_atomic_add v229, v226, s[28:31], 0 offen
    v_xor_b32 v196, 64, v233
    ds_read_b64 a[104:105], v196 offset:32768
    v_xor_b32 v197, 80, v233
    ds_read_b64 a[106:107], v197 offset:32768
    s_add_u32 s74, s74, 16384
    s_add_u32 m0, s70, 1024
    s_nop 0
    buffer_load_dwordx4 v231, s[12:15], s74 offen lds
    v_mfma_f32_32x32x16_bf16 v[48:63], v[124:127], a[44:47], v[48:63]
    ds_read_b64_tr_b16 v[108:109], v9 offset:34816
    ds_read_b64_tr_b16 v[110:111], v9 offset:35840
    s_add_u32 m0, s70, 65536
    s_nop 0
    buffer_load_dwordx4 v7, s[8:11], s83 offen offset:3072 lds
    v_xor_b32 v198, 96, v233
    ds_read_b64 a[108:109], v198 offset:32768
    v_xor_b32 v199, 112, v233
    ds_read_b64 a[110:111], v199 offset:32768
    s_waitcnt lgkmcnt(4)
    v_mfma_f32_32x32x16_bf16 v[32:47], v[96:99], a[48:51], v[32:47]
    ds_read_b64_tr_b16 v[112:113], v8 offset:36864
    ds_read_b64_tr_b16 v[114:115], v8 offset:37888
    s_add_u32 s74, s74, 16384
    s_add_u32 m0, s70, 2048
    s_nop 0
    buffer_load_dwordx4 v230, s[12:15], s74 offen lds
    v_mfma_f32_32x32x16_bf16 v[48:63], v[100:103], a[48:51], v[48:63]
    ds_read_b64_tr_b16 v[116:117], v9 offset:36864
    ds_read_b64_tr_b16 v[118:119], v9 offset:37888
    s_add_u32 s74, s74, 16384
    s_add_u32 m0, s70, 3072
    s_nop 0
    buffer_load_dwordx4 v231, s[12:15], s74 offen lds
    s_waitcnt lgkmcnt(4)
    v_mfma_f32_32x32x16_bf16 v[32:47], v[104:107], a[52:55], v[32:47]
    ds_read_b64_tr_b16 v[120:121], v8 offset:38912
    ds_read_b64_tr_b16 v[122:123], v8 offset:39936
    s_and_b32 s74, s61, 0xe000
    s_lshr_b32 s74, s74, 5
    s_add_u32 s74, s74, s38
    s_add_u32 s74, s74, 128
    s_add_u32 m0, s70, 98304
    s_nop 0
    buffer_load_dwordx4 v230, s[12:15], s74 offen lds
    v_mfma_f32_32x32x16_bf16 v[48:63], v[108:111], a[52:55], v[48:63]
    ds_read_b64_tr_b16 v[124:125], v9 offset:38912
    ds_read_b64_tr_b16 v[126:127], v9 offset:39936
    s_add_u32 s83, s68, s57
    s_add_u32 m0, s70, 81920
    s_nop 0
    buffer_load_dwordx4 v4, s[8:11], s83 offen lds
    s_waitcnt lgkmcnt(4)
    v_mfma_f32_32x32x16_bf16 v[32:47], v[112:115], a[56:59], v[32:47]
    ds_read_b64_tr_b16 v[96:97], v8 offset:40960
    ds_read_b64_tr_b16 v[98:99], v8 offset:41984
    s_waitcnt vmcnt(15)
    ds_read_b64 v[144:145], v233 offset:49152
    v_xor_b32 v193, 16, v233
    ds_read_b64 v[146:147], v193 offset:49152
    s_add_u32 s74, s74, 16384
    s_add_u32 m0, s70, 99328
    s_nop 0
    buffer_load_dwordx4 v231, s[12:15], s74 offen lds
    v_mfma_f32_32x32x16_bf16 v[48:63], v[116:119], a[56:59], v[48:63]
    ds_read_b64_tr_b16 v[100:101], v9 offset:40960
    ds_read_b64_tr_b16 v[102:103], v9 offset:41984
    v_xor_b32 v194, 32, v233
    ds_read_b64 v[148:149], v194 offset:49152
    v_xor_b32 v195, 48, v233
    ds_read_b64 v[150:151], v195 offset:49152
    s_add_u32 s74, s74, 16384
    s_add_u32 m0, s70, 100352
    s_nop 0
    buffer_load_dwordx4 v230, s[12:15], s74 offen lds
    s_waitcnt lgkmcnt(4)
    v_mfma_f32_32x32x16_bf16 v[32:47], v[120:123], a[60:63], v[32:47]
    ds_read_b64_tr_b16 v[104:105], v8 offset:43008
    ds_read_b64_tr_b16 v[106:107], v8 offset:44032
    v_xor_b32 v196, 64, v233
    ds_read_b64 v[152:153], v196 offset:49152
    v_xor_b32 v197, 80, v233
    ds_read_b64 v[154:155], v197 offset:49152
    s_add_u32 s74, s74, 16384
    s_add_u32 m0, s70, 101376
    s_nop 0
    buffer_load_dwordx4 v231, s[12:15], s74 offen lds
    v_mfma_f32_32x32x16_bf16 v[48:63], v[124:127], a[60:63], v[48:63]
    ds_read_b64_tr_b16 v[108:109], v9 offset:43008
    ds_read_b64_tr_b16 v[110:111], v9 offset:44032
    s_add_u32 m0, s70, 81920
    s_nop 0
    buffer_load_dwordx4 v5, s[8:11], s83 offen offset:1024 lds
    v_xor_b32 v198, 96, v233
    ds_read_b64 v[156:157], v198 offset:49152
    v_xor_b32 v199, 112, v233
    ds_read_b64 v[158:159], v199 offset:49152
    s_waitcnt lgkmcnt(4)
    v_mfma_f32_32x32x16_bf16 v[32:47], v[96:99], a[64:67], v[32:47]
    ds_read_b64_tr_b16 v[112:113], v8 offset:45056
    ds_read_b64_tr_b16 v[114:115], v8 offset:46080
    buffer_load_dwordx4 v[236:239], v2, s[8:11], s39 offen offset:1024
    v_add_u32 v12, 256, v12
    ds_read_b128 v[64:67], v12 offset:0
    ds_read_b128 v[68:71], v12 offset:32
    ds_read_b128 v[72:75], v12 offset:64
    ds_read_b128 v[76:79], v12 offset:96
    ds_read_b128 v[80:83], v12 offset:128
    ds_read_b128 v[84:87], v12 offset:160
    ds_read_b128 v[88:91], v12 offset:192
    ds_read_b128 v[92:95], v12 offset:224
    v_mfma_f32_32x32x16_bf16 v[48:63], v[100:103], a[64:67], v[48:63]
    ds_read_b64_tr_b16 v[116:117], v9 offset:45056
    ds_read_b64_tr_b16 v[118:119], v9 offset:46080
    s_waitcnt lgkmcnt(4)
    v_mfma_f32_32x32x16_bf16 v[32:47], v[104:107], a[68:71], v[32:47]
    ds_read_b64_tr_b16 v[120:121], v8 offset:47104
    ds_read_b64_tr_b16 v[122:123], v8 offset:48128
    s_and_b32 s74, s62, 0xe000
    s_lshr_b32 s74, s74, 5
    s_add_u32 s74, s74, s38
    s_add_u32 s74, s74, 128
    s_add_u32 m0, s70, 114688
    s_nop 0
    buffer_load_dwordx4 v230, s[12:15], s74 offen lds
    v_mfma_f32_32x32x16_bf16 v[48:63], v[108:111], a[68:71], v[48:63]
    ds_read_b64_tr_b16 v[124:125], v9 offset:47104
    ds_read_b64_tr_b16 v[126:127], v9 offset:48128
    s_add_u32 m0, s70, 81920
    s_nop 0
    buffer_load_dwordx4 v6, s[8:11], s83 offen offset:2048 lds
    s_waitcnt vmcnt(28)
    s_barrier
    s_waitcnt lgkmcnt(4)
    v_mfma_f32_32x32x16_bf16 v[32:47], v[112:115], a[72:75], v[32:47]
    ds_read_b64_tr_b16 v[96:97], v8 offset:49152
    ds_read_b64_tr_b16 v[98:99], v8 offset:50176
    s_add_u32 s74, s74, 16384
    s_add_u32 m0, s70, 115712
    s_nop 0
    buffer_load_dwordx4 v231, s[12:15], s74 offen lds
    v_mfma_f32_32x32x16_bf16 v[48:63], v[116:119], a[72:75], v[48:63]
    ds_read_b64_tr_b16 v[100:101], v9 offset:49152
    ds_read_b64_tr_b16 v[102:103], v9 offset:50176
    s_add_u32 s74, s74, 16384
    s_add_u32 m0, s70, 116736
    s_nop 0
    buffer_load_dwordx4 v230, s[12:15], s74 offen lds
    s_waitcnt lgkmcnt(4)
    v_mfma_f32_32x32x16_bf16 v[32:47], v[120:123], a[76:79], v[32:47]
    ds_read_b64_tr_b16 v[104:105], v8 offset:51200
    ds_read_b64_tr_b16 v[106:107], v8 offset:52224
    s_waitcnt vmcnt(6)
    ds_read_b64 a[112:113], v233 offset:32768
    v_xor_b32 v193, 16, v233
    ds_read_b64 a[114:115], v193 offset:32768
    s_add_u32 s74, s74, 16384
    s_add_u32 m0, s70, 117760
    s_nop 0
    buffer_load_dwordx4 v231, s[12:15], s74 offen lds
    v_mfma_f32_32x32x16_bf16 v[48:63], v[124:127], a[76:79], v[48:63]
    ds_read_b64_tr_b16 v[108:109], v9 offset:51200
    ds_read_b64_tr_b16 v[110:111], v9 offset:52224
    s_add_u32 m0, s70, 81920
    s_nop 0
    buffer_load_dwordx4 v7, s[8:11], s83 offen offset:3072 lds
    v_xor_b32 v194, 32, v233
    ds_read_b64 a[116:117], v194 offset:32768
    v_xor_b32 v195, 48, v233
    ds_read_b64 a[118:119], v195 offset:32768
    s_waitcnt lgkmcnt(4)
    v_mfma_f32_32x32x16_bf16 v[32:47], v[96:99], a[80:83], v[32:47]
    ds_read_b64_tr_b16 v[112:113], v8 offset:53248
    ds_read_b64_tr_b16 v[114:115], v8 offset:54272
    v_xor_b32 v196, 64, v233
    ds_read_b64 a[120:121], v196 offset:32768
    v_xor_b32 v197, 80, v233
    ds_read_b64 a[122:123], v197 offset:32768
    s_and_b32 s74, s64, 0xe000
    s_lshr_b32 s74, s74, 5
    s_add_u32 s74, s74, s38
    s_add_u32 s74, s74, 128
    s_add_u32 m0, s70, 16384
    s_nop 0
    buffer_load_dwordx4 v230, s[12:15], s74 offen lds
    v_mfma_f32_32x32x16_bf16 v[48:63], v[100:103], a[80:83], v[48:63]
    ds_read_b64_tr_b16 v[116:117], v9 offset:53248
    ds_read_b64_tr_b16 v[118:119], v9 offset:54272
    v_xor_b32 v198, 96, v233
    ds_read_b64 a[124:125], v198 offset:32768
    v_xor_b32 v199, 112, v233
    ds_read_b64 a[126:127], v199 offset:32768
    s_add_u32 s74, s74, 16384
    s_add_u32 m0, s70, 17408
    s_nop 0
    buffer_load_dwordx4 v231, s[12:15], s74 offen lds
    s_waitcnt lgkmcnt(4)
    v_mfma_f32_32x32x16_bf16 v[32:47], v[104:107], a[84:87], v[32:47]
    ds_read_b64_tr_b16 v[120:121], v8 offset:55296
    ds_read_b64_tr_b16 v[122:123], v8 offset:56320
    s_add_u32 s74, s74, 16384
    s_add_u32 m0, s70, 18432
    s_nop 0
    buffer_load_dwordx4 v230, s[12:15], s74 offen lds
    v_mfma_f32_32x32x16_bf16 v[48:63], v[108:111], a[84:87], v[48:63]
    ds_read_b64_tr_b16 v[124:125], v9 offset:55296
    ds_read_b64_tr_b16 v[126:127], v9 offset:56320
    s_add_u32 s83, s68, s58
    s_add_u32 m0, s70, 98304
    s_nop 0
    buffer_load_dwordx4 v4, s[8:11], s83 offen lds
    s_waitcnt lgkmcnt(4)
    v_mfma_f32_32x32x16_bf16 v[32:47], v[112:115], a[88:91], v[32:47]
    ds_read_b64_tr_b16 v[96:97], v8 offset:57344
    ds_read_b64_tr_b16 v[98:99], v8 offset:58368
    s_waitcnt vmcnt(17)
    ds_read_b64 a[144:145], v232 offset:0
    v_xor_b32 v193, 16, v232
    ds_read_b64 a[146:147], v193 offset:0
    s_add_u32 s74, s74, 16384
    s_add_u32 m0, s70, 19456
    s_nop 0
    buffer_load_dwordx4 v231, s[12:15], s74 offen lds
    v_mfma_f32_32x32x16_bf16 v[48:63], v[116:119], a[88:91], v[48:63]
    ds_read_b64_tr_b16 v[100:101], v9 offset:57344
    ds_read_b64_tr_b16 v[102:103], v9 offset:58368
    v_xor_b32 v194, 32, v232
    ds_read_b64 a[148:149], v194 offset:0
    v_xor_b32 v195, 48, v232
    ds_read_b64 a[150:151], v195 offset:0
    s_waitcnt lgkmcnt(4)
    v_mfma_f32_32x32x16_bf16 v[32:47], v[120:123], a[92:95], v[32:47]
    ds_read_b64_tr_b16 v[104:105], v8 offset:59392
    ds_read_b64_tr_b16 v[106:107], v8 offset:60416
    v_xor_b32 v196, 64, v232
    ds_read_b64 a[152:153], v196 offset:0
    v_xor_b32 v197, 80, v232
    ds_read_b64 a[154:155], v197 offset:0
    v_mfma_f32_32x32x16_bf16 v[48:63], v[124:127], a[92:95], v[48:63]
    ds_read_b64_tr_b16 v[108:109], v9 offset:59392
    ds_read_b64_tr_b16 v[110:111], v9 offset:60416
    s_add_u32 m0, s70, 98304
    s_nop 0
    buffer_load_dwordx4 v5, s[8:11], s83 offen offset:1024 lds
    v_xor_b32 v198, 96, v232
    ds_read_b64 a[156:157], v198 offset:0
    v_xor_b32 v199, 112, v232
    ds_read_b64 a[158:159], v199 offset:0
    s_waitcnt lgkmcnt(4)
    v_mfma_f32_32x32x16_bf16 v[32:47], v[96:99], a[96:99], v[32:47]
    ds_read_b64_tr_b16 v[112:113], v8 offset:61440
    ds_read_b64_tr_b16 v[114:115], v8 offset:62464
    v_mfma_f32_32x32x16_bf16 v[48:63], v[100:103], a[96:99], v[48:63]
    ds_read_b64_tr_b16 v[116:117], v9 offset:61440
    ds_read_b64_tr_b16 v[118:119], v9 offset:62464
    s_waitcnt lgkmcnt(4)
    v_mfma_f32_32x32x16_bf16 v[32:47], v[104:107], a[100:103], v[32:47]
    ds_read_b64_tr_b16 v[120:121], v8 offset:63488
    ds_read_b64_tr_b16 v[122:123], v8 offset:64512
    s_and_b32 s74, s65, 0xe000
    s_lshr_b32 s74, s74, 5
    s_add_u32 s74, s74, s38
    s_add_u32 s74, s74, 128
    s_add_u32 m0, s70, 0
    s_nop 0
    buffer_load_dwordx4 v230, s[12:15], s74 offen lds
    v_mfma_f32_32x32x16_bf16 v[48:63], v[108:111], a[100:103], v[48:63]
    ds_read_b64_tr_b16 v[124:125], v9 offset:63488
    ds_read_b64_tr_b16 v[126:127], v9 offset:64512
    s_add_u32 m0, s70, 98304
    s_nop 0
    buffer_load_dwordx4 v6, s[8:11], s83 offen offset:2048 lds
    s_waitcnt vmcnt(23)
    s_barrier
    s_waitcnt lgkmcnt(4)
    v_mfma_f32_32x32x16_bf16 v[32:47], v[112:115], a[104:107], v[32:47]
    ds_read_b64_tr_b16 v[96:97], v10 offset:0
    ds_read_b64_tr_b16 v[98:99], v10 offset:1024
    s_waitcnt vmcnt(9)
    ds_read_b64 a[128:129], v233 offset:49152
    v_xor_b32 v193, 16, v233
    ds_read_b64 a[130:131], v193 offset:49152
    s_add_u32 s74, s74, 16384
    s_add_u32 m0, s70, 1024
    s_nop 0
    buffer_load_dwordx4 v231, s[12:15], s74 offen lds
    v_mfma_f32_32x32x16_bf16 v[48:63], v[116:119], a[104:107], v[48:63]
    ds_read_b64_tr_b16 v[100:101], v11 offset:0
    ds_read_b64_tr_b16 v[102:103], v11 offset:1024
    v_xor_b32 v194, 32, v233
    ds_read_b64 a[132:133], v194 offset:49152
    v_xor_b32 v195, 48, v233
    ds_read_b64 a[134:135], v195 offset:49152
    s_add_u32 s74, s74, 16384
    s_add_u32 m0, s70, 2048
    s_nop 0
    buffer_load_dwordx4 v230, s[12:15], s74 offen lds
    s_waitcnt lgkmcnt(4)
    v_mfma_f32_32x32x16_bf16 v[32:47], v[120:123], a[108:111], v[32:47]
    ds_read_b64_tr_b16 v[104:105], v10 offset:2048
    ds_read_b64_tr_b16 v[106:107], v10 offset:3072
    v_xor_b32 v196, 64, v233
    ds_read_b64 a[136:137], v196 offset:49152
    v_xor_b32 v197, 80, v233
    ds_read_b64 a[138:139], v197 offset:49152
    s_add_u32 s74, s74, 16384
    s_add_u32 m0, s70, 3072
    s_nop 0
    buffer_load_dwordx4 v231, s[12:15], s74 offen lds
    v_mfma_f32_32x32x16_bf16 v[48:63], v[124:127], a[108:111], v[48:63]
    ds_read_b64_tr_b16 v[108:109], v11 offset:2048
    ds_read_b64_tr_b16 v[110:111], v11 offset:3072
    s_add_u32 m0, s70, 98304
    s_nop 0
    buffer_load_dwordx4 v7, s[8:11], s83 offen offset:3072 lds
    v_xor_b32 v198, 96, v233
    ds_read_b64 a[140:141], v198 offset:49152
    v_xor_b32 v199, 112, v233
    ds_read_b64 a[142:143], v199 offset:49152
    s_waitcnt lgkmcnt(4)
    v_mfma_f32_32x32x16_bf16 v[32:47], v[96:99], v[144:147], v[32:47]
    ds_read_b64_tr_b16 v[112:113], v10 offset:4096
    ds_read_b64_tr_b16 v[114:115], v10 offset:5120
    s_and_b32 s74, s67, 0xe000
    s_lshr_b32 s74, s74, 5
    s_add_u32 s74, s74, s38
    s_add_u32 s74, s74, 128
    s_add_u32 m0, s70, 32768
    s_nop 0
    buffer_load_dwordx4 v230, s[12:15], s74 offen lds
    v_mfma_f32_32x32x16_bf16 v[48:63], v[100:103], v[144:147], v[48:63]
    ds_read_b64_tr_b16 v[116:117], v11 offset:4096
    ds_read_b64_tr_b16 v[118:119], v11 offset:5120
    s_add_u32 s74, s74, 16384
    s_add_u32 m0, s70, 33792
    s_nop 0
    buffer_load_dwordx4 v231, s[12:15], s74 offen lds
    s_waitcnt lgkmcnt(4)
    v_mfma_f32_32x32x16_bf16 v[32:47], v[104:107], v[148:151], v[32:47]
    ds_read_b64_tr_b16 v[120:121], v10 offset:6144
    ds_read_b64_tr_b16 v[122:123], v10 offset:7168
    s_add_u32 s74, s74, 16384
    s_add_u32 m0, s70, 34816
    s_nop 0
    buffer_load_dwordx4 v230, s[12:15], s74 offen lds
    v_mov_b32 v176, v144
    v_mov_b32 v177, v145
    v_mov_b32 v178, v146
    v_mov_b32 v179, v147
    v_mfma_f32_32x32x16_bf16 v[48:63], v[108:111], v[148:151], v[48:63]
    ds_read_b64_tr_b16 v[124:125], v11 offset:6144
    ds_read_b64_tr_b16 v[126:127], v11 offset:7168
    s_add_u32 s83, s68, s59
    s_add_u32 m0, s70, 114688
    s_nop 0
    buffer_load_dwordx4 v4, s[8:11], s83 offen lds
    v_mov_b32 v180, v148
    v_mov_b32 v181, v149
    v_mov_b32 v182, v150
    v_mov_b32 v183, v151
    s_waitcnt lgkmcnt(4)
    v_mfma_f32_32x32x16_bf16 v[32:47], v[112:115], v[152:155], v[32:47]
    ds_read_b64_tr_b16 v[96:97], v10 offset:8192
    ds_read_b64_tr_b16 v[98:99], v10 offset:9216
    s_waitcnt vmcnt(11)
    ds_read_b64 a[160:161], v232 offset:16384
    v_xor_b32 v193, 16, v232
    ds_read_b64 a[162:163], v193 offset:16384
    s_add_u32 s74, s74, 16384
    s_add_u32 m0, s70, 35840
    s_nop 0
    buffer_load_dwordx4 v231, s[12:15], s74 offen lds
    v_mov_b32 v184, v152
    v_mov_b32 v185, v153
    v_mov_b32 v186, v154
    v_mov_b32 v187, v155
    v_mfma_f32_32x32x16_bf16 v[48:63], v[116:119], v[152:155], v[48:63]
    ds_read_b64_tr_b16 v[100:101], v11 offset:8192
    ds_read_b64_tr_b16 v[102:103], v11 offset:9216
    v_xor_b32 v194, 32, v232
    ds_read_b64 a[164:165], v194 offset:16384
    v_xor_b32 v195, 48, v232
    ds_read_b64 a[166:167], v195 offset:16384
    v_mov_b32 v188, v156
    v_mov_b32 v189, v157
    v_mov_b32 v190, v158
    v_mov_b32 v191, v159
    s_waitcnt lgkmcnt(4)
    v_mfma_f32_32x32x16_bf16 v[32:47], v[120:123], v[156:159], v[32:47]
    ds_read_b64_tr_b16 v[104:105], v10 offset:10240
    ds_read_b64_tr_b16 v[106:107], v10 offset:11264
    v_xor_b32 v196, 64, v232
    ds_read_b64 a[168:169], v196 offset:16384
    v_xor_b32 v197, 80, v232
    ds_read_b64 a[170:171], v197 offset:16384
    v_mfma_f32_32x32x16_bf16 v[48:63], v[124:127], v[156:159], v[48:63]
    ds_read_b64_tr_b16 v[108:109], v11 offset:10240
    ds_read_b64_tr_b16 v[110:111], v11 offset:11264
    s_add_u32 m0, s70, 114688
    s_nop 0
    buffer_load_dwordx4 v5, s[8:11], s83 offen offset:1024 lds
    v_xor_b32 v198, 96, v232
    ds_read_b64 a[172:173], v198 offset:16384
    v_xor_b32 v199, 112, v232
    ds_read_b64 a[174:175], v199 offset:16384
    s_waitcnt lgkmcnt(4)
    v_mfma_f32_32x32x16_bf16 v[32:47], v[96:99], a[112:115], v[32:47]
    ds_read_b64_tr_b16 v[112:113], v10 offset:12288
    ds_read_b64_tr_b16 v[114:115], v10 offset:13312
    v_mfma_f32_32x32x16_bf16 v[48:63], v[100:103], a[112:115], v[48:63]
    ds_read_b64_tr_b16 v[116:117], v11 offset:12288
    ds_read_b64_tr_b16 v[118:119], v11 offset:13312
    s_waitcnt lgkmcnt(4)
    v_mfma_f32_32x32x16_bf16 v[32:47], v[104:107], a[116:119], v[32:47]
    ds_read_b64_tr_b16 v[120:121], v10 offset:14336
    ds_read_b64_tr_b16 v[122:123], v10 offset:15360
    s_and_b32 s74, s66, 0xe000
    s_lshr_b32 s74, s74, 5
    s_add_u32 s74, s74, s38
    s_add_u32 s74, s74, 128
    s_add_u32 m0, s70, 16384
    s_nop 0
    buffer_load_dwordx4 v230, s[12:15], s74 offen lds
    v_mfma_f32_32x32x16_bf16 v[48:63], v[108:111], a[116:119], v[48:63]
    ds_read_b64_tr_b16 v[124:125], v11 offset:14336
    ds_read_b64_tr_b16 v[126:127], v11 offset:15360
    s_add_u32 m0, s70, 114688
    s_nop 0
    buffer_load_dwordx4 v6, s[8:11], s83 offen offset:2048 lds
    s_waitcnt vmcnt(20)
    s_barrier
    s_waitcnt lgkmcnt(4)
    v_mfma_f32_32x32x16_bf16 v[32:47], v[112:115], a[120:123], v[32:47]
    ds_read_b64_tr_b16 v[96:97], v10 offset:16384
    ds_read_b64_tr_b16 v[98:99], v10 offset:17408
    s_add_u32 s74, s74, 16384
    s_add_u32 m0, s70, 17408
    s_nop 0
    buffer_load_dwordx4 v231, s[12:15], s74 offen lds
    v_mfma_f32_32x32x16_bf16 v[48:63], v[116:119], a[120:123], v[48:63]
    ds_read_b64_tr_b16 v[100:101], v11 offset:16384
    ds_read_b64_tr_b16 v[102:103], v11 offset:17408
    s_add_u32 s74, s74, 16384
    s_add_u32 m0, s70, 18432
    s_nop 0
    buffer_load_dwordx4 v230, s[12:15], s74 offen lds
    s_waitcnt lgkmcnt(4)
    v_mfma_f32_32x32x16_bf16 v[32:47], v[120:123], a[124:127], v[32:47]
    ds_read_b64_tr_b16 v[104:105], v10 offset:18432
    ds_read_b64_tr_b16 v[106:107], v10 offset:19456
    s_waitcnt vmcnt(11)
    ds_read_b64 a[176:177], v232 offset:0
    v_xor_b32 v193, 16, v232
    ds_read_b64 a[178:179], v193 offset:0
    s_add_u32 s74, s74, 16384
    s_add_u32 m0, s70, 19456
    s_nop 0
    buffer_load_dwordx4 v231, s[12:15], s74 offen lds
    v_mfma_f32_32x32x16_bf16 v[48:63], v[124:127], a[124:127], v[48:63]
    ds_read_b64_tr_b16 v[108:109], v11 offset:18432
    ds_read_b64_tr_b16 v[110:111], v11 offset:19456
    s_add_u32 m0, s70, 114688
    s_nop 0
    buffer_load_dwordx4 v7, s[8:11], s83 offen offset:3072 lds
    v_xor_b32 v194, 32, v232
    ds_read_b64 a[180:181], v194 offset:0
    v_xor_b32 v195, 48, v232
    ds_read_b64 a[182:183], v195 offset:0
    s_waitcnt lgkmcnt(4)
    v_mfma_f32_32x32x16_bf16 v[32:47], v[96:99], a[128:131], v[32:47]
    ds_read_b64_tr_b16 v[112:113], v10 offset:20480
    ds_read_b64_tr_b16 v[114:115], v10 offset:21504
    v_xor_b32 v196, 64, v232
    ds_read_b64 a[184:185], v196 offset:0
    v_xor_b32 v197, 80, v232
    ds_read_b64 a[186:187], v197 offset:0
    v_mfma_f32_32x32x16_bf16 v[48:63], v[100:103], a[128:131], v[48:63]
    ds_read_b64_tr_b16 v[116:117], v11 offset:20480
    ds_read_b64_tr_b16 v[118:119], v11 offset:21504
    v_xor_b32 v198, 96, v232
    ds_read_b64 a[188:189], v198 offset:0
    v_xor_b32 v199, 112, v232
    ds_read_b64 a[190:191], v199 offset:0
    s_waitcnt lgkmcnt(4)
    v_mfma_f32_32x32x16_bf16 v[32:47], v[104:107], a[132:135], v[32:47]
    ds_read_b64_tr_b16 v[120:121], v10 offset:22528
    ds_read_b64_tr_b16 v[122:123], v10 offset:23552
    v_mfma_f32_32x32x16_bf16 v[48:63], v[108:111], a[132:135], v[48:63]
    ds_read_b64_tr_b16 v[124:125], v11 offset:22528
    ds_read_b64_tr_b16 v[126:127], v11 offset:23552
    s_add_u32 s83, s69, s52
    s_add_u32 m0, s70, 0
    s_nop 0
    buffer_load_dwordx4 v4, s[8:11], s83 offen lds
    s_waitcnt lgkmcnt(4)
    v_mfma_f32_32x32x16_bf16 v[32:47], v[112:115], a[136:139], v[32:47]
    ds_read_b64_tr_b16 v[96:97], v10 offset:24576
    ds_read_b64_tr_b16 v[98:99], v10 offset:25600
    v_mfma_f32_32x32x16_bf16 v[48:63], v[116:119], a[136:139], v[48:63]
    ds_read_b64_tr_b16 v[100:101], v11 offset:24576
    ds_read_b64_tr_b16 v[102:103], v11 offset:25600
    s_waitcnt lgkmcnt(4)
    v_mfma_f32_32x32x16_bf16 v[32:47], v[120:123], a[140:143], v[32:47]
    ds_read_b64_tr_b16 v[104:105], v10 offset:26624
    ds_read_b64_tr_b16 v[106:107], v10 offset:27648
    v_mfma_f32_32x32x16_bf16 v[48:63], v[124:127], a[140:143], v[48:63]
    ds_read_b64_tr_b16 v[108:109], v11 offset:26624
    ds_read_b64_tr_b16 v[110:111], v11 offset:27648
    s_add_u32 m0, s70, 0
    s_nop 0
    buffer_load_dwordx4 v5, s[8:11], s83 offen offset:1024 lds
    s_waitcnt lgkmcnt(4)
    v_mfma_f32_32x32x16_bf16 v[32:47], v[96:99], a[144:147], v[32:47]
    ds_read_b64_tr_b16 v[112:113], v10 offset:28672
    ds_read_b64_tr_b16 v[114:115], v10 offset:29696
    s_waitcnt vmcnt(9)
    ds_read_b64 a[208:209], v232 offset:32768
    v_xor_b32 v193, 16, v232
    ds_read_b64 a[210:211], v193 offset:32768
    v_mfma_f32_32x32x16_bf16 v[48:63], v[100:103], a[144:147], v[48:63]
    ds_read_b64_tr_b16 v[116:117], v11 offset:28672
    ds_read_b64_tr_b16 v[118:119], v11 offset:29696
    v_xor_b32 v194, 32, v232
    ds_read_b64 a[212:213], v194 offset:32768
    v_xor_b32 v195, 48, v232
    ds_read_b64 a[214:215], v195 offset:32768
    s_waitcnt lgkmcnt(4)
    v_mfma_f32_32x32x16_bf16 v[32:47], v[104:107], a[148:151], v[32:47]
    ds_read_b64_tr_b16 v[120:121], v10 offset:30720
    ds_read_b64_tr_b16 v[122:123], v10 offset:31744
    v_xor_b32 v196, 64, v232
    ds_read_b64 a[216:217], v196 offset:32768
    v_xor_b32 v197, 80, v232
    ds_read_b64 a[218:219], v197 offset:32768
    v_mfma_f32_32x32x16_bf16 v[48:63], v[108:111], a[148:151], v[48:63]
    ds_read_b64_tr_b16 v[124:125], v11 offset:30720
    ds_read_b64_tr_b16 v[126:127], v11 offset:31744
    s_add_u32 m0, s70, 0
    s_nop 0
    buffer_load_dwordx4 v6, s[8:11], s83 offen offset:2048 lds
    v_xor_b32 v198, 96, v232
    ds_read_b64 a[220:221], v198 offset:32768
    v_xor_b32 v199, 112, v232
    ds_read_b64 a[222:223], v199 offset:32768
    s_waitcnt vmcnt(15)
    s_barrier
    s_waitcnt lgkmcnt(4)
    v_mfma_f32_32x32x16_bf16 v[32:47], v[112:115], a[152:155], v[32:47]
    ds_read_b64_tr_b16 v[96:97], v10 offset:32768
    ds_read_b64_tr_b16 v[98:99], v10 offset:33792
    v_mfma_f32_32x32x16_bf16 v[48:63], v[116:119], a[152:155], v[48:63]
    ds_read_b64_tr_b16 v[100:101], v11 offset:32768
    ds_read_b64_tr_b16 v[102:103], v11 offset:33792
    s_waitcnt lgkmcnt(4)
    v_mfma_f32_32x32x16_bf16 v[32:47], v[120:123], a[156:159], v[32:47]
    ds_read_b64_tr_b16 v[104:105], v10 offset:34816
    ds_read_b64_tr_b16 v[106:107], v10 offset:35840
    s_waitcnt vmcnt(4)
    ds_read_b64 a[192:193], v232 offset:16384
    v_xor_b32 v193, 16, v232
    ds_read_b64 a[194:195], v193 offset:16384
    v_mfma_f32_32x32x16_bf16 v[48:63], v[124:127], a[156:159], v[48:63]
    ds_read_b64_tr_b16 v[108:109], v11 offset:34816
    ds_read_b64_tr_b16 v[110:111], v11 offset:35840
    s_add_u32 m0, s70, 0
    s_nop 0
    buffer_load_dwordx4 v7, s[8:11], s83 offen offset:3072 lds
    v_xor_b32 v194, 32, v232
    ds_read_b64 a[196:197], v194 offset:16384
    v_xor_b32 v195, 48, v232
    ds_read_b64 a[198:199], v195 offset:16384
    s_waitcnt lgkmcnt(4)
    v_mfma_f32_32x32x16_bf16 v[32:47], v[96:99], a[160:163], v[32:47]
    ds_read_b64_tr_b16 v[112:113], v10 offset:36864
    ds_read_b64_tr_b16 v[114:115], v10 offset:37888
    v_xor_b32 v196, 64, v232
    ds_read_b64 a[200:201], v196 offset:16384
    v_xor_b32 v197, 80, v232
    ds_read_b64 a[202:203], v197 offset:16384
    v_mfma_f32_32x32x16_bf16 v[48:63], v[100:103], a[160:163], v[48:63]
    ds_read_b64_tr_b16 v[116:117], v11 offset:36864
    ds_read_b64_tr_b16 v[118:119], v11 offset:37888
    v_xor_b32 v198, 96, v232
    ds_read_b64 a[204:205], v198 offset:16384
    v_xor_b32 v199, 112, v232
    ds_read_b64 a[206:207], v199 offset:16384
    s_waitcnt lgkmcnt(4)
    v_mfma_f32_32x32x16_bf16 v[32:47], v[104:107], a[164:167], v[32:47]
    ds_read_b64_tr_b16 v[120:121], v10 offset:38912
    ds_read_b64_tr_b16 v[122:123], v10 offset:39936
    v_mfma_f32_32x32x16_bf16 v[48:63], v[108:111], a[164:167], v[48:63]
    ds_read_b64_tr_b16 v[124:125], v11 offset:38912
    ds_read_b64_tr_b16 v[126:127], v11 offset:39936
    s_add_u32 s83, s69, s53
    s_add_u32 m0, s70, 16384
    s_nop 0
    buffer_load_dwordx4 v4, s[8:11], s83 offen lds
    s_waitcnt lgkmcnt(4)
    v_mfma_f32_32x32x16_bf16 v[32:47], v[112:115], a[168:171], v[32:47]
    ds_read_b64_tr_b16 v[96:97], v10 offset:40960
    ds_read_b64_tr_b16 v[98:99], v10 offset:41984
    buffer_load_dword v17, v225, s[28:31], 0 offen sc1
    v_mfma_f32_32x32x16_bf16 v[48:63], v[116:119], a[168:171], v[48:63]
    ds_read_b64_tr_b16 v[100:101], v11 offset:40960
    ds_read_b64_tr_b16 v[102:103], v11 offset:41984
    s_waitcnt lgkmcnt(4)
    v_mfma_f32_32x32x16_bf16 v[32:47], v[120:123], a[172:175], v[32:47]
    ds_read_b64_tr_b16 v[104:105], v10 offset:43008
    ds_read_b64_tr_b16 v[106:107], v10 offset:44032
    v_mfma_f32_32x32x16_bf16 v[48:63], v[124:127], a[172:175], v[48:63]
    ds_read_b64_tr_b16 v[108:109], v11 offset:43008
    ds_read_b64_tr_b16 v[110:111], v11 offset:44032
    s_add_u32 m0, s70, 16384
    s_nop 0
    buffer_load_dwordx4 v5, s[8:11], s83 offen offset:1024 lds
    s_waitcnt lgkmcnt(4)
    v_mfma_f32_32x32x16_bf16 v[32:47], v[96:99], a[176:179], v[32:47]
    ds_read_b64_tr_b16 v[112:113], v10 offset:45056
    ds_read_b64_tr_b16 v[114:115], v10 offset:46080
    v_mfma_f32_32x32x16_bf16 v[48:63], v[100:103], a[176:179], v[48:63]
    ds_read_b64_tr_b16 v[116:117], v11 offset:45056
    ds_read_b64_tr_b16 v[118:119], v11 offset:46080
    s_waitcnt lgkmcnt(4)
    v_mfma_f32_32x32x16_bf16 v[32:47], v[104:107], a[180:183], v[32:47]
    ds_read_b64_tr_b16 v[120:121], v10 offset:47104
    ds_read_b64_tr_b16 v[122:123], v10 offset:48128
    v_mfma_f32_32x32x16_bf16 v[48:63], v[108:111], a[180:183], v[48:63]
    ds_read_b64_tr_b16 v[124:125], v11 offset:47104
    ds_read_b64_tr_b16 v[126:127], v11 offset:48128
    s_add_u32 m0, s70, 16384
    s_nop 0
    buffer_load_dwordx4 v6, s[8:11], s83 offen offset:2048 lds
    s_waitcnt vmcnt(8)
    s_barrier
    s_waitcnt lgkmcnt(4)
    v_mfma_f32_32x32x16_bf16 v[32:47], v[112:115], a[184:187], v[32:47]
    ds_read_b64_tr_b16 v[96:97], v10 offset:49152
    ds_read_b64_tr_b16 v[98:99], v10 offset:50176
    v_mfma_f32_32x32x16_bf16 v[48:63], v[116:119], a[184:187], v[48:63]
    ds_read_b64_tr_b16 v[100:101], v11 offset:49152
    ds_read_b64_tr_b16 v[102:103], v11 offset:50176
    s_waitcnt lgkmcnt(4)
    v_mfma_f32_32x32x16_bf16 v[32:47], v[120:123], a[188:191], v[32:47]
    ds_read_b64_tr_b16 v[104:105], v10 offset:51200
    ds_read_b64_tr_b16 v[106:107], v10 offset:52224
    v_mfma_f32_32x32x16_bf16 v[48:63], v[124:127], a[188:191], v[48:63]
    ds_read_b64_tr_b16 v[108:109], v11 offset:51200
    ds_read_b64_tr_b16 v[110:111], v11 offset:52224
    s_add_u32 m0, s70, 16384
    s_nop 0
    buffer_load_dwordx4 v7, s[8:11], s83 offen offset:3072 lds
    s_waitcnt lgkmcnt(4)
    v_mfma_f32_32x32x16_bf16 v[32:47], v[96:99], a[192:195], v[32:47]
    ds_read_b64_tr_b16 v[112:113], v10 offset:53248
    ds_read_b64_tr_b16 v[114:115], v10 offset:54272
    v_mfma_f32_32x32x16_bf16 v[48:63], v[100:103], a[192:195], v[48:63]
    ds_read_b64_tr_b16 v[116:117], v11 offset:53248
    ds_read_b64_tr_b16 v[118:119], v11 offset:54272
    s_waitcnt lgkmcnt(4)
    v_mfma_f32_32x32x16_bf16 v[32:47], v[104:107], a[196:199], v[32:47]
    ds_read_b64_tr_b16 v[120:121], v10 offset:55296
    ds_read_b64_tr_b16 v[122:123], v10 offset:56320
    v_mfma_f32_32x32x16_bf16 v[48:63], v[108:111], a[196:199], v[48:63]
    ds_read_b64_tr_b16 v[124:125], v11 offset:55296
    ds_read_b64_tr_b16 v[126:127], v11 offset:56320
    s_add_u32 s83, s69, s54
    s_add_u32 m0, s70, 32768
    s_nop 0
    buffer_load_dwordx4 v4, s[8:11], s83 offen lds
    s_waitcnt lgkmcnt(4)
    v_mfma_f32_32x32x16_bf16 v[32:47], v[112:115], a[200:203], v[32:47]
    ds_read_b64_tr_b16 v[96:97], v10 offset:57344
    ds_read_b64_tr_b16 v[98:99], v10 offset:58368
    v_mfma_f32_32x32x16_bf16 v[48:63], v[116:119], a[200:203], v[48:63]
    ds_read_b64_tr_b16 v[100:101], v11 offset:57344
    ds_read_b64_tr_b16 v[102:103], v11 offset:58368
    s_waitcnt lgkmcnt(4)
    v_mfma_f32_32x32x16_bf16 v[32:47], v[120:123], a[204:207], v[32:47]
    ds_read_b64_tr_b16 v[104:105], v10 offset:59392
    ds_read_b64_tr_b16 v[106:107], v10 offset:60416
    v_mfma_f32_32x32x16_bf16 v[48:63], v[124:127], a[204:207], v[48:63]
    ds_read_b64_tr_b16 v[108:109], v11 offset:59392
    ds_read_b64_tr_b16 v[110:111], v11 offset:60416
    s_add_u32 m0, s70, 32768
    s_nop 0
    buffer_load_dwordx4 v5, s[8:11], s83 offen offset:1024 lds
    s_waitcnt lgkmcnt(4)
    v_mfma_f32_32x32x16_bf16 v[32:47], v[96:99], a[208:211], v[32:47]
    ds_read_b64_tr_b16 v[112:113], v10 offset:61440
    ds_read_b64_tr_b16 v[114:115], v10 offset:62464
    v_mfma_f32_32x32x16_bf16 v[48:63], v[100:103], a[208:211], v[48:63]
    ds_read_b64_tr_b16 v[116:117], v11 offset:61440
    ds_read_b64_tr_b16 v[118:119], v11 offset:62464
    s_waitcnt lgkmcnt(4)
    v_mfma_f32_32x32x16_bf16 v[32:47], v[104:107], a[212:215], v[32:47]
    ds_read_b64_tr_b16 v[120:121], v10 offset:63488
    ds_read_b64_tr_b16 v[122:123], v10 offset:64512
    v_mfma_f32_32x32x16_bf16 v[48:63], v[108:111], a[212:215], v[48:63]
    ds_read_b64_tr_b16 v[124:125], v11 offset:63488
    ds_read_b64_tr_b16 v[126:127], v11 offset:64512
    s_add_u32 m0, s70, 32768
    s_nop 0
    buffer_load_dwordx4 v6, s[8:11], s83 offen offset:2048 lds
    s_waitcnt vmcnt(8)
    s_barrier
    s_waitcnt lgkmcnt(4)
    v_mfma_f32_32x32x16_bf16 v[32:47], v[112:115], a[216:219], v[32:47]
    ds_read_b64_tr_b16 v[96:97], v8 offset:0
    ds_read_b64_tr_b16 v[98:99], v8 offset:1024
    s_waitcnt vmcnt(6)
    v_readfirstlane_b32 s75, v17
    s_nop 1
    s_and_b32 s76, s75, 0x0f0f0f0f
    s_lshr_b32 s77, s75, 4
    s_and_b32 s77, s77, 0x0f0f0f0f
    s_add_u32 s76, s76, s77
    s_mul_i32 s76, s76, 0x01010101
    s_lshr_b32 s76, s76, 24
    s_lshl_b32 s77, s37, 2
    s_lshr_b32 s77, s75, s77
    s_and_b32 s77, s77, 15
    s_cmp_eq_u32 s77, 8
    s_cselect_b32 s36, 1, 0
    s_cmp_ge_u32 s76, 8
    s_cbranch_scc0 Lslow_9
Lrok_1:
    v_mfma_f32_32x32x16_bf16 v[48:63], v[116:119], a[216:219], v[48:63]
    ds_read_b64_tr_b16 v[100:101], v9 offset:0
    ds_read_b64_tr_b16 v[102:103], v9 offset:1024
    s_waitcnt lgkmcnt(4)
    v_mfma_f32_32x32x16_bf16 v[32:47], v[120:123], a[220:223], v[32:47]
    ds_read_b64_tr_b16 v[104:105], v8 offset:2048
    ds_read_b64_tr_b16 v[106:107], v8 offset:3072
    v_mfma_f32_32x32x16_bf16 v[48:63], v[124:127], a[220:223], v[48:63]
    ds_read_b64_tr_b16 v[108:109], v9 offset:2048
    ds_read_b64_tr_b16 v[110:111], v9 offset:3072
    s_add_u32 m0, s70, 32768
    s_nop 0
    buffer_load_dwordx4 v7, s[8:11], s83 offen offset:3072 lds
    s_add_u32 s35, s35, 1
    s_mov_b32 s68, s69
    s_add_u32 s69, s68, 2097024
    s_cmp_ge_u32 s35, 5
    s_cselect_b32 s69, 0x7f000000, s69
L_odd:
    s_sub_u32 s75, s35, 1
    s_lshr_b32 s75, s75, 1
    s_mov_b32 s71, 0
    s_add_u32 s72, s60, s71
    s_waitcnt lgkmcnt(4)
    v_mfma_f32_32x32x16_bf16 v[64:79], v[96:99], v[128:131], v[64:79]
    ds_read_b64_tr_b16 v[112:113], v8 offset:4096
    ds_read_b64_tr_b16 v[114:115], v8 offset:5120
    v_mfma_f32_32x32x16_bf16 v[80:95], v[100:103], v[128:131], v[80:95]
    ds_read_b64_tr_b16 v[116:117], v9 offset:4096
    ds_read_b64_tr_b16 v[118:119], v9 offset:5120
    s_add_u32 s83, s68, s55
    s_add_u32 m0, s70, 49152
    s_nop 0
    buffer_load_dwordx4 v4, s[8:11], s83 offen lds
    s_waitcnt lgkmcnt(4)
    v_mfma_f32_32x32x16_bf16 v[64:79], v[104:107], v[132:135], v[64:79]
    ds_read_b64_tr_b16 v[120:121], v8 offset:6144
    ds_read_b64_tr_b16 v[122:123], v8 offset:7168
    v_mfma_f32_32x32x16_bf16 v[80:95], v[108:111], v[132:135], v[80:95]
    ds_read_b64_tr_b16 v[124:125], v9 offset:6144
    ds_read_b64_tr_b16 v[126:127], v9 offset:7168
    buffer_load_dwordx4 v5, s[8:11], s83 offen offset:1024 lds
    s_waitcnt lgkmcnt(4)
    v_mfma_f32_32x32x16_bf16 v[64:79], v[112:115], v[136:139], v[64:79]
    ds_read_b64_tr_b16 v[96:97], v8 offset:8192
    ds_read_b64_tr_b16 v[98:99], v8 offset:9216
    v_mfma_f32_32x32x16_bf16 v[80:95], v[116:119], v[136:139], v[80:95]
    ds_read_b64_tr_b16 v[100:101], v9 offset:8192
    ds_read_b64_tr_b16 v[102:103], v9 offset:9216
    buffer_load_dwordx4 v6, s[8:11], s83 offen offset:2048 lds
    s_waitcnt lgkmcnt(4)
    v_mfma_f32_32x32x16_bf16 v[64:79], v[120:123], v[140:143], v[64:79]
    ds_read_b64_tr_b16 v[104:105], v8 offset:10240
    ds_read_b64_tr_b16 v[106:107], v8 offset:11264
    v_mfma_f32_32x32x16_bf16 v[80:95], v[124:127], v[140:143], v[80:95]
    ds_read_b64_tr_b16 v[108:109], v9 offset:10240
    ds_read_b64_tr_b16 v[110:111], v9 offset:11264
    buffer_load_dwordx4 v7, s[8:11], s83 offen offset:3072 lds
    s_waitcnt lgkmcnt(4)
    v_mfma_f32_32x32x16_bf16 v[64:79], v[96:99], a[0:3], v[64:79]
    ds_read_b64_tr_b16 v[112:113], v8 offset:12288
    ds_read_b64_tr_b16 v[114:115], v8 offset:13312
    v_lshlrev_b32 v192, 16, v160
    v_and_b32 v193, s79, v160
    v_lshlrev_b32 v194, 16, v128
    v_and_b32 v195, s79, v128
    v_mfma_f32_32x32x16_bf16 v[80:95], v[100:103], a[0:3], v[80:95]
    ds_read_b64_tr_b16 v[116:117], v9 offset:12288
    ds_read_b64_tr_b16 v[118:119], v9 offset:13312
    s_add_u32 s83, s68, s56
    s_add_u32 m0, s70, 65536
    s_nop 0
    buffer_load_dwordx4 v4, s[8:11], s83 offen lds
    v_fma_f32 v194, v192, v32, v194
    v_fma_f32 v195, v193, v33, v195
    v_cvt_pk_bf16_f32 v128, v194, v195
    v_lshlrev_b32 v196, 16, v161
    s_waitcnt lgkmcnt(4)
    v_mfma_f32_32x32x16_bf16 v[64:79], v[104:107], a[4:7], v[64:79]
    ds_read_b64_tr_b16 v[120:121], v8 offset:14336
    ds_read_b64_tr_b16 v[122:123], v8 offset:15360
    v_and_b32 v197, s79, v161
    v_lshlrev_b32 v198, 16, v129
    v_and_b32 v199, s79, v129
    v_fma_f32 v198, v196, v34, v198
    v_mfma_f32_32x32x16_bf16 v[80:95], v[108:111], a[4:7], v[80:95]
    ds_read_b64_tr_b16 v[124:125], v9 offset:14336
    ds_read_b64_tr_b16 v[126:127], v9 offset:15360
    buffer_load_dwordx4 v5, s[8:11], s83 offen offset:1024 lds
    v_fma_f32 v199, v197, v35, v199
    v_cvt_pk_bf16_f32 v129, v198, v199
    v_lshlrev_b32 v200, 16, v162
    v_and_b32 v201, s79, v162
    s_waitcnt vmcnt(10)
    s_barrier
    s_waitcnt lgkmcnt(4)
    v_mfma_f32_32x32x16_bf16 v[64:79], v[112:115], a[8:11], v[64:79]
    ds_read_b64_tr_b16 v[96:97], v8 offset:16384
    ds_read_b64_tr_b16 v[98:99], v8 offset:17408
    v_lshlrev_b32 v202, 16, v130
    v_and_b32 v203, s79, v130
    v_fma_f32 v202, v200, v36, v202
    v_fma_f32 v203, v201, v37, v203
    v_mfma_f32_32x32x16_bf16 v[80:95], v[116:119], a[8:11], v[80:95]
    ds_read_b64_tr_b16 v[100:101], v9 offset:16384
    ds_read_b64_tr_b16 v[102:103], v9 offset:17408
    buffer_load_dwordx4 v6, s[8:11], s83 offen offset:2048 lds
    v_cvt_pk_bf16_f32 v130, v202, v203
    v_lshlrev_b32 v204, 16, v163
    v_and_b32 v205, s79, v163
    v_lshlrev_b32 v206, 16, v131
    s_waitcnt lgkmcnt(4)
    v_mfma_f32_32x32x16_bf16 v[64:79], v[120:123], a[12:15], v[64:79]
    ds_read_b64_tr_b16 v[104:105], v8 offset:18432
    ds_read_b64_tr_b16 v[106:107], v8 offset:19456
    v_and_b32 v207, s79, v131
    v_fma_f32 v206, v204, v38, v206
    v_fma_f32 v207, v205, v39, v207
    v_cvt_pk_bf16_f32 v131, v206, v207
    v_mfma_f32_32x32x16_bf16 v[80:95], v[124:127], a[12:15], v[80:95]
    ds_read_b64_tr_b16 v[108:109], v9 offset:18432
    ds_read_b64_tr_b16 v[110:111], v9 offset:19456
    buffer_load_dwordx4 v7, s[8:11], s83 offen offset:3072 lds
    s_waitcnt lgkmcnt(4)
    v_mfma_f32_32x32x16_bf16 v[64:79], v[96:99], a[16:19], v[64:79]
    ds_read_b64_tr_b16 v[112:113], v8 offset:20480
    ds_read_b64_tr_b16 v[114:115], v8 offset:21504
    buffer_store_dwordx4 v[128:131], v2, s[16:19], s72 offen offset:0 sc1
    v_lshlrev_b32 v192, 16, v164
    v_and_b32 v193, s79, v164
    v_lshlrev_b32 v194, 16, v132
    v_and_b32 v195, s79, v132
    v_mfma_f32_32x32x16_bf16 v[80:95], v[100:103], a[16:19], v[80:95]
    ds_read_b64_tr_b16 v[116:117], v9 offset:20480
    ds_read_b64_tr_b16 v[118:119], v9 offset:21504
    s_add_u32 s83, s68, s57
    s_add_u32 m0, s70, 81920
    s_nop 0
    buffer_load_dwordx4 v4, s[8:11], s83 offen lds
    v_fma_f32 v194, v192, v40, v194
    v_fma_f32 v195, v193, v41, v195
    v_cvt_pk_bf16_f32 v132, v194, v195
    v_lshlrev_b32 v196, 16, v165
    s_waitcnt lgkmcnt(4)
    v_mfma_f32_32x32x16_bf16 v[64:79], v[104:107], a[20:23], v[64:79]
    ds_read_b64_tr_b16 v[120:121], v8 offset:22528
    ds_read_b64_tr_b16 v[122:123], v8 offset:23552
    v_and_b32 v197, s79, v165
    v_lshlrev_b32 v198, 16, v133
    v_and_b32 v199, s79, v133
    v_fma_f32 v198, v196, v42, v198
    v_mfma_f32_32x32x16_bf16 v[80:95], v[108:111], a[20:23], v[80:95]
    ds_read_b64_tr_b16 v[124:125], v9 offset:22528
    ds_read_b64_tr_b16 v[126:127], v9 offset:23552
    buffer_load_dwordx4 v5, s[8:11], s83 offen offset:1024 lds
    v_fma_f32 v199, v197, v43, v199
    v_cvt_pk_bf16_f32 v133, v198, v199
    v_lshlrev_b32 v200, 16, v166
    v_and_b32 v201, s79, v166
    s_waitcnt lgkmcnt(4)
    v_mfma_f32_32x32x16_bf16 v[64:79], v[112:115], a[24:27], v[64:79]
    ds_read_b64_tr_b16 v[96:97], v8 offset:24576
    ds_read_b64_tr_b16 v[98:99], v8 offset:25600
    v_lshlrev_b32 v202, 16, v134
    v_and_b32 v203, s79, v134
    v_fma_f32 v202, v200, v44, v202
    v_fma_f32 v203, v201, v45, v203
    v_mfma_f32_32x32x16_bf16 v[80:95], v[116:119], a[24:27], v[80:95]
    ds_read_b64_tr_b16 v[100:101], v9 offset:24576
    ds_read_b64_tr_b16 v[102:103], v9 offset:25600
    buffer_load_dwordx4 v6, s[8:11], s83 offen offset:2048 lds
    v_cvt_pk_bf16_f32 v134, v202, v203
    v_lshlrev_b32 v204, 16, v167
    v_and_b32 v205, s79, v167
    v_lshlrev_b32 v206, 16, v135
    s_waitcnt lgkmcnt(4)
    v_mfma_f32_32x32x16_bf16 v[64:79], v[120:123], a[28:31], v[64:79]
    ds_read_b64_tr_b16 v[104:105], v8 offset:26624
    ds_read_b64_tr_b16 v[106:107], v8 offset:27648
    v_and_b32 v207, s79, v135
    v_fma_f32 v206, v204, v46, v206
    v_fma_f32 v207, v205, v47, v207
    v_cvt_pk_bf16_f32 v135, v206, v207
    v_mfma_f32_32x32x16_bf16 v[80:95], v[124:127], a[28:31], v[80:95]
    ds_read_b64_tr_b16 v[108:109], v9 offset:26624
    ds_read_b64_tr_b16 v[110:111], v9 offset:27648
    buffer_load_dwordx4 v7, s[8:11], s83 offen offset:3072 lds
    s_waitcnt lgkmcnt(4)
    v_mfma_f32_32x32x16_bf16 v[64:79], v[96:99], a[32:35], v[64:79]
    ds_read_b64_tr_b16 v[112:113], v8 offset:28672
    ds_read_b64_tr_b16 v[114:115], v8 offset:29696
    buffer_store_dwordx4 v[132:135], v2, s[16:19], s72 offen offset:1024 sc1
    v_lshlrev_b32 v192, 16, v168
    v_and_b32 v193, s79, v168
    v_lshlrev_b32 v194, 16, v136
    v_and_b32 v195, s79, v136
    v_mfma_f32_32x32x16_bf16 v[80:95], v[100:103], a[32:35], v[80:95]
    ds_read_b64_tr_b16 v[116:117], v9 offset:28672
    ds_read_b64_tr_b16 v[118:119], v9 offset:29696
    s_add_u32 s83, s68, s58
    s_add_u32 m0, s70, 98304
    s_nop 0
    buffer_load_dwordx4 v4, s[8:11], s83 offen lds
    v_fma_f32 v194, v192, v48, v194
    v_fma_f32 v195, v193, v49, v195
    v_cvt_pk_bf16_f32 v136, v194, v195
    v_lshlrev_b32 v196, 16, v169
    s_waitcnt lgkmcnt(4)
    v_mfma_f32_32x32x16_bf16 v[64:79], v[104:107], a[36:39], v[64:79]
    ds_read_b64_tr_b16 v[120:121], v8 offset:30720
    ds_read_b64_tr_b16 v[122:123], v8 offset:31744
    v_and_b32 v197, s79, v169
    v_lshlrev_b32 v198, 16, v137
    v_and_b32 v199, s79, v137
    v_fma_f32 v198, v196, v50, v198
    v_mfma_f32_32x32x16_bf16 v[80:95], v[108:111], a[36:39], v[80:95]
    ds_read_b64_tr_b16 v[124:125], v9 offset:30720
    ds_read_b64_tr_b16 v[126:127], v9 offset:31744
    buffer_load_dwordx4 v5, s[8:11], s83 offen offset:1024 lds
    v_fma_f32 v199, v197, v51, v199
    v_cvt_pk_bf16_f32 v137, v198, v199
    v_lshlrev_b32 v200, 16, v170
    v_and_b32 v201, s79, v170
    s_waitcnt vmcnt(16)
    s_barrier
    s_waitcnt lgkmcnt(4)
    v_mfma_f32_32x32x16_bf16 v[64:79], v[112:115], a[40:43], v[64:79]
    ds_read_b64_tr_b16 v[96:97], v8 offset:32768
    ds_read_b64_tr_b16 v[98:99], v8 offset:33792
    v_lshlrev_b32 v202, 16, v138
    v_and_b32 v203, s79, v138
    v_fma_f32 v202, v200, v52, v202
    v_fma_f32 v203, v201, v53, v203
    v_mfma_f32_32x32x16_bf16 v[80:95], v[116:119], a[40:43], v[80:95]
    ds_read_b64_tr_b16 v[100:101], v9 offset:32768
    ds_read_b64_tr_b16 v[102:103], v9 offset:33792
    buffer_load_dwordx4 v6, s[8:11], s83 offen offset:2048 lds
    v_cvt_pk_bf16_f32 v138, v202, v203
    v_lshlrev_b32 v204, 16, v171
    v_and_b32 v205, s79, v171
    v_lshlrev_b32 v206, 16, v139
    s_waitcnt lgkmcnt(4)
    v_mfma_f32_32x32x16_bf16 v[64:79], v[120:123], a[44:47], v[64:79]
    ds_read_b64_tr_b16 v[104:105], v8 offset:34816
    ds_read_b64_tr_b16 v[106:107], v8 offset:35840
    v_and_b32 v207, s79, v139
    v_fma_f32 v206, v204, v54, v206
    v_fma_f32 v207, v205, v55, v207
    v_cvt_pk_bf16_f32 v139, v206, v207
    v_mfma_f32_32x32x16_bf16 v[80:95], v[124:127], a[44:47], v[80:95]
    ds_read_b64_tr_b16 v[108:109], v9 offset:34816
    ds_read_b64_tr_b16 v[110:111], v9 offset:35840
    buffer_load_dwordx4 v7, s[8:11], s83 offen offset:3072 lds
    s_waitcnt lgkmcnt(4)
    v_mfma_f32_32x32x16_bf16 v[64:79], v[96:99], a[48:51], v[64:79]
    ds_read_b64_tr_b16 v[112:113], v8 offset:36864
    ds_read_b64_tr_b16 v[114:115], v8 offset:37888
    buffer_store_dwordx4 v[136:139], v2, s[16:19], s72 offen offset:2048 sc1
    v_lshlrev_b32 v192, 16, v172
    v_and_b32 v193, s79, v172
    v_lshlrev_b32 v194, 16, v140
    v_and_b32 v195, s79, v140
    v_mfma_f32_32x32x16_bf16 v[80:95], v[100:103], a[48:51], v[80:95]
    ds_read_b64_tr_b16 v[116:117], v9 offset:36864
    ds_read_b64_tr_b16 v[118:119], v9 offset:37888
    s_add_u32 s83, s68, s59
    s_add_u32 m0, s70, 114688
    s_nop 0
    buffer_load_dwordx4 v4, s[8:11], s83 offen lds
    v_fma_f32 v194, v192, v56, v194
    v_fma_f32 v195, v193, v57, v195
    v_cvt_pk_bf16_f32 v140, v194, v195
    v_lshlrev_b32 v196, 16, v173
    s_waitcnt lgkmcnt(4)
    v_mfma_f32_32x32x16_bf16 v[64:79], v[104:107], a[52:55], v[64:79]
    ds_read_b64_tr_b16 v[120:121], v8 offset:38912
    ds_read_b64_tr_b16 v[122:123], v8 offset:39936
    v_and_b32 v197, s79, v173
    v_lshlrev_b32 v198, 16, v141
    v_and_b32 v199, s79, v141
    v_fma_f32 v198, v196, v58, v198
    v_mfma_f32_32x32x16_bf16 v[80:95], v[108:111], a[52:55], v[80:95]
    ds_read_b64_tr_b16 v[124:125], v9 offset:38912
    ds_read_b64_tr_b16 v[126:127], v9 offset:39936
    buffer_load_dwordx4 v5, s[8:11], s83 offen offset:1024 lds
    v_fma_f32 v199, v197, v59, v199
    v_cvt_pk_bf16_f32 v141, v198, v199
    v_lshlrev_b32 v200, 16, v174
    v_and_b32 v201, s79, v174
    s_waitcnt lgkmcnt(4)
    v_mfma_f32_32x32x16_bf16 v[64:79], v[112:115], a[56:59], v[64:79]
    ds_read_b64_tr_b16 v[96:97], v8 offset:40960
    ds_read_b64_tr_b16 v[98:99], v8 offset:41984
    v_lshlrev_b32 v202, 16, v142
    v_and_b32 v203, s79, v142
    v_fma_f32 v202, v200, v60, v202
    v_fma_f32 v203, v201, v61, v203
    v_mfma_f32_32x32x16_bf16 v[80:95], v[116:119], a[56:59], v[80:95]
    ds_read_b64_tr_b16 v[100:101], v9 offset:40960
    ds_read_b64_tr_b16 v[102:103], v9 offset:41984
    buffer_load_dwordx4 v6, s[8:11], s83 offen offset:2048 lds
    v_cvt_pk_bf16_f32 v142, v202, v203
    v_lshlrev_b32 v204, 16, v175
    v_and_b32 v205, s79, v175
    v_lshlrev_b32 v206, 16, v143
    s_waitcnt lgkmcnt(4)
    v_mfma_f32_32x32x16_bf16 v[64:79], v[120:123], a[60:63], v[64:79]
    ds_read_b64_tr_b16 v[104:105], v8 offset:43008
    ds_read_b64_tr_b16 v[106:107], v8 offset:44032
    v_and_b32 v207, s79, v143
    v_fma_f32 v206, v204, v62, v206
    v_fma_f32 v207, v205, v63, v207
    v_cvt_pk_bf16_f32 v143, v206, v207
    v_mfma_f32_32x32x16_bf16 v[80:95], v[124:127], a[60:63], v[80:95]
    ds_read_b64_tr_b16 v[108:109], v9 offset:43008
    ds_read_b64_tr_b16 v[110:111], v9 offset:44032
    buffer_load_dwordx4 v7, s[8:11], s83 offen offset:3072 lds
    s_waitcnt lgkmcnt(4)
    v_mfma_f32_32x32x16_bf16 v[64:79], v[96:99], a[64:67], v[64:79]
    ds_read_b64_tr_b16 v[112:113], v8 offset:45056
    ds_read_b64_tr_b16 v[114:115], v8 offset:46080
    buffer_store_dwordx4 v[140:143], v2, s[16:19], s72 offen offset:3072 sc1
    v_mfma_f32_32x32x16_bf16 v[80:95], v[100:103], a[64:67], v[80:95]
    ds_read_b64_tr_b16 v[116:117], v9 offset:45056
    ds_read_b64_tr_b16 v[118:119], v9 offset:46080
    s_add_u32 s83, s69, s52
    s_add_u32 m0, s70, 0
    s_nop 0
    buffer_load_dwordx4 v4, s[8:11], s83 offen lds
    s_waitcnt lgkmcnt(4)
    v_mfma_f32_32x32x16_bf16 v[64:79], v[104:107], a[68:71], v[64:79]
    ds_read_b64_tr_b16 v[120:121], v8 offset:47104
    ds_read_b64_tr_b16 v[122:123], v8 offset:48128
    v_mfma_f32_32x32x16_bf16 v[80:95], v[108:111], a[68:71], v[80:95]
    ds_read_b64_tr_b16 v[124:125], v9 offset:47104
    ds_read_b64_tr_b16 v[126:127], v9 offset:48128
    buffer_load_dwordx4 v5, s[8:11], s83 offen offset:1024 lds
    v_add_u32 v12, 256, v12
    ds_read_b128 v[32:35], v12 offset:0
    ds_read_b128 v[36:39], v12 offset:32
    ds_read_b128 v[40:43], v12 offset:64
    ds_read_b128 v[44:47], v12 offset:96
    ds_read_b128 v[48:51], v12 offset:128
    ds_read_b128 v[52:55], v12 offset:160
    ds_read_b128 v[56:59], v12 offset:192
    ds_read_b128 v[60:63], v12 offset:224
    s_waitcnt vmcnt(22)
    s_barrier
    s_waitcnt lgkmcnt(4)
    v_mfma_f32_32x32x16_bf16 v[64:79], v[112:115], a[72:75], v[64:79]
    ds_read_b64_tr_b16 v[96:97], v8 offset:49152
    ds_read_b64_tr_b16 v[98:99], v8 offset:50176
    v_mfma_f32_32x32x16_bf16 v[80:95], v[116:119], a[72:75], v[80:95]
    ds_read_b64_tr_b16 v[100:101], v9 offset:49152
    ds_read_b64_tr_b16 v[102:103], v9 offset:50176
    buffer_load_dwordx4 v6, s[8:11], s83 offen offset:2048 lds
    s_waitcnt lgkmcnt(4)
    v_mfma_f32_32x32x16_bf16 v[64:79], v[120:123], a[76:79], v[64:79]
    ds_read_b64_tr_b16 v[104:105], v8 offset:51200
    ds_read_b64_tr_b16 v[106:107], v8 offset:52224
    v_mfma_f32_32x32x16_bf16 v[80:95], v[124:127], a[76:79], v[80:95]
    ds_read_b64_tr_b16 v[108:109], v9 offset:51200
    ds_read_b64_tr_b16 v[110:111], v9 offset:52224
    buffer_load_dwordx4 v7, s[8:11], s83 offen offset:3072 lds
    s_waitcnt lgkmcnt(4)
    v_mfma_f32_32x32x16_bf16 v[64:79], v[96:99], a[80:83], v[64:79]
    ds_read_b64_tr_b16 v[112:113], v8 offset:53248
    ds_read_b64_tr_b16 v[114:115], v8 offset:54272
    v_mov_b32 v16, s35
    s_waitcnt vmcnt(4)
    buffer_store_dword v16, v15, s[16:19], s73 offen sc1
    v_mfma_f32_32x32x16_bf16 v[80:95], v[100:103], a[80:83], v[80:95]
    ds_read_b64_tr_b16 v[116:117], v9 offset:53248
    ds_read_b64_tr_b16 v[118:119], v9 offset:54272
    s_add_u32 s83, s69, s53
    s_add_u32 m0, s70, 16384
    s_nop 0
    buffer_load_dwordx4 v4, s[8:11], s83 offen lds
    s_waitcnt lgkmcnt(4)
    v_mfma_f32_32x32x16_bf16 v[64:79], v[104:107], a[84:87], v[64:79]
    ds_read_b64_tr_b16 v[120:121], v8 offset:55296
    ds_read_b64_tr_b16 v[122:123], v8 offset:56320
    v_mfma_f32_32x32x16_bf16 v[80:95], v[108:111], a[84:87], v[80:95]
    ds_read_b64_tr_b16 v[124:125], v9 offset:55296
    ds_read_b64_tr_b16 v[126:127], v9 offset:56320
    buffer_load_dwordx4 v5, s[8:11], s83 offen offset:1024 lds
    s_waitcnt lgkmcnt(4)
    v_mfma_f32_32x32x16_bf16 v[64:79], v[112:115], a[88:91], v[64:79]
    ds_read_b64_tr_b16 v[96:97], v8 offset:57344
    ds_read_b64_tr_b16 v[98:99], v8 offset:58368
    v_mfma_f32_32x32x16_bf16 v[80:95], v[116:119], a[88:91], v[80:95]
    ds_read_b64_tr_b16 v[100:101], v9 offset:57344
    ds_read_b64_tr_b16 v[102:103], v9 offset:58368
    buffer_load_dwordx4 v6, s[8:11], s83 offen offset:2048 lds
    s_waitcnt lgkmcnt(4)
    v_mfma_f32_32x32x16_bf16 v[64:79], v[120:123], a[92:95], v[64:79]
    ds_read_b64_tr_b16 v[104:105], v8 offset:59392
    ds_read_b64_tr_b16 v[106:107], v8 offset:60416
    v_mfma_f32_32x32x16_bf16 v[80:95], v[124:127], a[92:95], v[80:95]
    ds_read_b64_tr_b16 v[108:109], v9 offset:59392
    ds_read_b64_tr_b16 v[110:111], v9 offset:60416
    buffer_load_dwordx4 v7, s[8:11], s83 offen offset:3072 lds
    s_waitcnt lgkmcnt(4)
    v_mfma_f32_32x32x16_bf16 v[64:79], v[96:99], a[96:99], v[64:79]
    ds_read_b64_tr_b16 v[112:113], v8 offset:61440
    ds_read_b64_tr_b16 v[114:115], v8 offset:62464
    v_mfma_f32_32x32x16_bf16 v[80:95], v[100:103], a[96:99], v[80:95]
    ds_read_b64_tr_b16 v[116:117], v9 offset:61440
    ds_read_b64_tr_b16 v[118:119], v9 offset:62464
    s_waitcnt lgkmcnt(4)
    v_mfma_f32_32x32x16_bf16 v[64:79], v[104:107], a[100:103], v[64:79]
    ds_read_b64_tr_b16 v[120:121], v8 offset:63488
    ds_read_b64_tr_b16 v[122:123], v8 offset:64512
    v_mfma_f32_32x32x16_bf16 v[80:95], v[108:111], a[100:103], v[80:95]
    ds_read_b64_tr_b16 v[124:125], v9 offset:63488
    ds_read_b64_tr_b16 v[126:127], v9 offset:64512
    s_waitcnt vmcnt(25)
    s_barrier
    s_waitcnt lgkmcnt(4)
    v_mfma_f32_32x32x16_bf16 v[64:79], v[112:115], a[104:107], v[64:79]
    ds_read_b64_tr_b16 v[96:97], v10 offset:0
    ds_read_b64_tr_b16 v[98:99], v10 offset:1024
    v_mfma_f32_32x32x16_bf16 v[80:95], v[116:119], a[104:107], v[80:95]
    ds_read_b64_tr_b16 v[100:101], v11 offset:0
    ds_read_b64_tr_b16 v[102:103], v11 offset:1024
    s_add_u32 s83, s69, s54
    s_add_u32 m0, s70, 32768
    s_nop 0
    buffer_load_dwordx4 v4, s[8:11], s83 offen lds
    s_waitcnt lgkmcnt(4)
    v_mfma_f32_32x32x16_bf16 v[64:79], v[120:123], a[108:111], v[64:79]
    ds_read_b64_tr_b16 v[104:105], v10 offset:2048
    ds_read_b64_tr_b16 v[106:107], v10 offset:3072
    v_mfma_f32_32x32x16_bf16 v[80:95], v[124:127], a[108:111], v[80:95]
    ds_read_b64_tr_b16 v[108:109], v11 offset:2048
    ds_read_b64_tr_b16 v[110:111], v11 offset:3072
    buffer_load_dwordx4 v5, s[8:11], s83 offen offset:1024 lds
    s_waitcnt lgkmcnt(4)
    v_mfma_f32_32x32x16_bf16 v[64:79], v[96:99], v[144:147], v[64:79]
    ds_read_b64_tr_b16 v[112:113], v10 offset:4096
    ds_read_b64_tr_b16 v[114:115], v10 offset:5120
    v_mfma_f32_32x32x16_bf16 v[80:95], v[100:103], v[144:147], v[80:95]
    ds_read_b64_tr_b16 v[116:117], v11 offset:4096
    ds_read_b64_tr_b16 v[118:119], v11 offset:5120
    buffer_load_dwordx4 v6, s[8:11], s83 offen offset:2048 lds
    s_waitcnt lgkmcnt(4)
    v_mfma_f32_32x32x16_bf16 v[64:79], v[104:107], v[148:151], v[64:79]
    ds_read_b64_tr_b16 v[120:121], v10 offset:6144
    ds_read_b64_tr_b16 v[122:123], v10 offset:7168
    v_mfma_f32_32x32x16_bf16 v[80:95], v[108:111], v[148:151], v[80:95]
    ds_read_b64_tr_b16 v[124:125], v11 offset:6144
    ds_read_b64_tr_b16 v[126:127], v11 offset:7168
    buffer_load_dwordx4 v7, s[8:11], s83 offen offset:3072 lds
    s_waitcnt lgkmcnt(4)
    v_mfma_f32_32x32x16_bf16 v[64:79], v[112:115], v[152:155], v[64:79]
    ds_read_b64_tr_b16 v[96:97], v10 offset:8192
    ds_read_b64_tr_b16 v[98:99], v10 offset:9216
    v_mfma_f32_32x32x16_bf16 v[80:95], v[116:119], v[152:155], v[80:95]
    ds_read_b64_tr_b16 v[100:101], v11 offset:8192
    ds_read_b64_tr_b16 v[102:103], v11 offset:9216
    s_waitcnt lgkmcnt(4)
    v_mfma_f32_32x32x16_bf16 v[64:79], v[120:123], v[156:159], v[64:79]
    ds_read_b64_tr_b16 v[104:105], v10 offset:10240
    ds_read_b64_tr_b16 v[106:107], v10 offset:11264
    v_mfma_f32_32x32x16_bf16 v[80:95], v[124:127], v[156:159], v[80:95]
    ds_read_b64_tr_b16 v[108:109], v11 offset:10240
    ds_read_b64_tr_b16 v[110:111], v11 offset:11264
    s_waitcnt lgkmcnt(4)
    v_mfma_f32_32x32x16_bf16 v[64:79], v[96:99], a[112:115], v[64:79]
    ds_read_b64_tr_b16 v[112:113], v10 offset:12288
    ds_read_b64_tr_b16 v[114:115], v10 offset:13312
    s_load_dwordx8 s[40:47], s[50:51], s82 glc
    v_mfma_f32_32x32x16_bf16 v[80:95], v[100:103], a[112:115], v[80:95]
    ds_read_b64_tr_b16 v[116:117], v11 offset:12288
    ds_read_b64_tr_b16 v[118:119], v11 offset:13312
    s_waitcnt lgkmcnt(4)
    v_mfma_f32_32x32x16_bf16 v[64:79], v[104:107], a[116:119], v[64:79]
    ds_read_b64_tr_b16 v[120:121], v10 offset:14336
    ds_read_b64_tr_b16 v[122:123], v10 offset:15360
    v_mfma_f32_32x32x16_bf16 v[80:95], v[108:111], a[116:119], v[80:95]
    ds_read_b64_tr_b16 v[124:125], v11 offset:14336
    ds_read_b64_tr_b16 v[126:127], v11 offset:15360
    s_waitcnt vmcnt(24)
    s_barrier
    s_waitcnt lgkmcnt(4)
    v_mfma_f32_32x32x16_bf16 v[64:79], v[112:115], a[120:123], v[64:79]
    ds_read_b64_tr_b16 v[96:97], v10 offset:16384
    ds_read_b64_tr_b16 v[98:99], v10 offset:17408
    v_mfma_f32_32x32x16_bf16 v[80:95], v[116:119], a[120:123], v[80:95]
    ds_read_b64_tr_b16 v[100:101], v11 offset:16384
    ds_read_b64_tr_b16 v[102:103], v11 offset:17408
    s_waitcnt lgkmcnt(4)
    v_mfma_f32_32x32x16_bf16 v[64:79], v[120:123], a[124:127], v[64:79]
    ds_read_b64_tr_b16 v[104:105], v10 offset:18432
    ds_read_b64_tr_b16 v[106:107], v10 offset:19456
    v_mfma_f32_32x32x16_bf16 v[80:95], v[124:127], a[124:127], v[80:95]
    ds_read_b64_tr_b16 v[108:109], v11 offset:18432
    ds_read_b64_tr_b16 v[110:111], v11 offset:19456
    s_waitcnt lgkmcnt(4)
    v_mfma_f32_32x32x16_bf16 v[64:79], v[96:99], a[128:131], v[64:79]
    ds_read_b64_tr_b16 v[112:113], v10 offset:20480
    ds_read_b64_tr_b16 v[114:115], v10 offset:21504
    s_waitcnt lgkmcnt(0)
    s_min_u32 s40, s40, s41
    s_min_u32 s42, s42, s43
    s_min_u32 s44, s44, s45
    s_min_u32 s46, s46, s47
    s_min_u32 s40, s40, s42
    s_min_u32 s44, s44, s46
    s_min_u32 s40, s40, s44
    s_cmp_ge_u32 s40, s35
    s_cbranch_scc0 Lslow_10
Lpok_3:
    v_mfma_f32_32x32x16_bf16 v[80:95], v[100:103], a[128:131], v[80:95]
    ds_read_b64_tr_b16 v[116:117], v11 offset:20480
    ds_read_b64_tr_b16 v[118:119], v11 offset:21504
    s_add_u32 s76, s61, s71
    buffer_load_dwordx4 a[0:3], v2, s[16:19], s76 offen offset:0 sc1
    s_waitcnt lgkmcnt(4)
    v_mfma_f32_32x32x16_bf16 v[64:79], v[104:107], a[132:135], v[64:79]
    ds_read_b64_tr_b16 v[120:121], v10 offset:22528
    ds_read_b64_tr_b16 v[122:123], v10 offset:23552
    v_mfma_f32_32x32x16_bf16 v[80:95], v[108:111], a[132:135], v[80:95]
    ds_read_b64_tr_b16 v[124:125], v11 offset:22528
    ds_read_b64_tr_b16 v[126:127], v11 offset:23552
    buffer_load_dwordx4 a[4:7], v2, s[16:19], s76 offen offset:1024 sc1
    s_waitcnt lgkmcnt(4)
    v_mfma_f32_32x32x16_bf16 v[64:79], v[112:115], a[136:139], v[64:79]
    ds_read_b64_tr_b16 v[96:97], v10 offset:24576
    ds_read_b64_tr_b16 v[98:99], v10 offset:25600
    buffer_load_dwordx4 a[8:11], v2, s[16:19], s76 offen offset:2048 sc1
    v_mfma_f32_32x32x16_bf16 v[80:95], v[116:119], a[136:139], v[80:95]
    ds_read_b64_tr_b16 v[100:101], v11 offset:24576
    ds_read_b64_tr_b16 v[102:103], v11 offset:25600
    s_waitcnt lgkmcnt(4)
    v_mfma_f32_32x32x16_bf16 v[64:79], v[120:123], a[140:143], v[64:79]
    ds_read_b64_tr_b16 v[104:105], v10 offset:26624
    ds_read_b64_tr_b16 v[106:107], v10 offset:27648
    buffer_load_dwordx4 a[12:15], v2, s[16:19], s76 offen offset:3072 sc1
    s_add_u32 s76, s62, s71
    v_mfma_f32_32x32x16_bf16 v[80:95], v[124:127], a[140:143], v[80:95]
    ds_read_b64_tr_b16 v[108:109], v11 offset:26624
    ds_read_b64_tr_b16 v[110:111], v11 offset:27648
    buffer_load_dwordx4 a[16:19], v2, s[16:19], s76 offen offset:0 sc1
    s_waitcnt lgkmcnt(4)
    v_mfma_f32_32x32x16_bf16 v[64:79], v[96:99], a[144:147], v[64:79]
    ds_read_b64_tr_b16 v[112:113], v10 offset:28672
    ds_read_b64_tr_b16 v[114:115], v10 offset:29696
    v_mfma_f32_32x32x16_bf16 v[80:95], v[100:103], a[144:147], v[80:95]
    ds_read_b64_tr_b16 v[116:117], v11 offset:28672
    ds_read_b64_tr_b16 v[118:119], v11 offset:29696
    buffer_load_dwordx4 a[20:23], v2, s[16:19], s76 offen offset:1024 sc1
    s_waitcnt lgkmcnt(4)
    v_mfma_f32_32x32x16_bf16 v[64:79], v[104:107], a[148:151], v[64:79]
    ds_read_b64_tr_b16 v[120:121], v10 offset:30720
    ds_read_b64_tr_b16 v[122:123], v10 offset:31744
    buffer_load_dwordx4 a[24:27], v2, s[16:19], s76 offen offset:2048 sc1
    v_mfma_f32_32x32x16_bf16 v[80:95], v[108:111], a[148:151], v[80:95]
    ds_read_b64_tr_b16 v[124:125], v11 offset:30720
    ds_read_b64_tr_b16 v[126:127], v11 offset:31744
    s_waitcnt vmcnt(26)
    s_barrier
    s_waitcnt lgkmcnt(4)
    v_mfma_f32_32x32x16_bf16 v[64:79], v[112:115], a[152:155], v[64:79]
    ds_read_b64_tr_b16 v[96:97], v10 offset:32768
    ds_read_b64_tr_b16 v[98:99], v10 offset:33792
    buffer_load_dwordx4 a[28:31], v2, s[16:19], s76 offen offset:3072 sc1
    s_add_u32 s76, s63, s71
    v_mfma_f32_32x32x16_bf16 v[80:95], v[116:119], a[152:155], v[80:95]
    ds_read_b64_tr_b16 v[100:101], v11 offset:32768
    ds_read_b64_tr_b16 v[102:103], v11 offset:33792
    buffer_load_dwordx4 a[32:35], v2, s[16:19], s76 offen offset:0 sc1
    s_waitcnt lgkmcnt(4)
    v_mfma_f32_32x32x16_bf16 v[64:79], v[120:123], a[156:159], v[64:79]
    ds_read_b64_tr_b16 v[104:105], v10 offset:34816
    ds_read_b64_tr_b16 v[106:107], v10 offset:35840
    v_mfma_f32_32x32x16_bf16 v[80:95], v[124:127], a[156:159], v[80:95]
    ds_read_b64_tr_b16 v[108:109], v11 offset:34816
    ds_read_b64_tr_b16 v[110:111], v11 offset:35840
    buffer_load_dwordx4 a[36:39], v2, s[16:19], s76 offen offset:1024 sc1
    s_waitcnt lgkmcnt(4)
    v_mfma_f32_32x32x16_bf16 v[64:79], v[96:99], a[160:163], v[64:79]
    ds_read_b64_tr_b16 v[112:113], v10 offset:36864
    ds_read_b64_tr_b16 v[114:115], v10 offset:37888
    buffer_load_dwordx4 a[40:43], v2, s[16:19], s76 offen offset:2048 sc1
    v_mfma_f32_32x32x16_bf16 v[80:95], v[100:103], a[160:163], v[80:95]
    ds_read_b64_tr_b16 v[116:117], v11 offset:36864
    ds_read_b64_tr_b16 v[118:119], v11 offset:37888
    s_waitcnt lgkmcnt(4)
    v_mfma_f32_32x32x16_bf16 v[64:79], v[104:107], a[164:167], v[64:79]
    ds_read_b64_tr_b16 v[120:121], v10 offset:38912
    ds_read_b64_tr_b16 v[122:123], v10 offset:39936
    buffer_load_dwordx4 a[44:47], v2, s[16:19], s76 offen offset:3072 sc1
    s_add_u32 s76, s64, s71
    v_mfma_f32_32x32x16_bf16 v[80:95], v[108:111], a[164:167], v[80:95]
    ds_read_b64_tr_b16 v[124:125], v11 offset:38912
    ds_read_b64_tr_b16 v[126:127], v11 offset:39936
    buffer_load_dwordx4 a[48:51], v2, s[16:19], s76 offen offset:0 sc1
    s_waitcnt lgkmcnt(4)
    v_mfma_f32_32x32x16_bf16 v[64:79], v[112:115], a[168:171], v[64:79]
    ds_read_b64_tr_b16 v[96:97], v10 offset:40960
    ds_read_b64_tr_b16 v[98:99], v10 offset:41984
    v_mfma_f32_32x32x16_bf16 v[80:95], v[116:119], a[168:171], v[80:95]
    ds_read_b64_tr_b16 v[100:101], v11 offset:40960
    ds_read_b64_tr_b16 v[102:103], v11 offset:41984
    buffer_load_dwordx4 a[52:55], v2, s[16:19], s76 offen offset:1024 sc1
    s_waitcnt lgkmcnt(4)
    v_mfma_f32_32x32x16_bf16 v[64:79], v[120:123], a[172:175], v[64:79]
    ds_read_b64_tr_b16 v[104:105], v10 offset:43008
    ds_read_b64_tr_b16 v[106:107], v10 offset:44032
    buffer_load_dwordx4 a[56:59], v2, s[16:19], s76 offen offset:2048 sc1
    v_mfma_f32_32x32x16_bf16 v[80:95], v[124:127], a[172:175], v[80:95]
    ds_read_b64_tr_b16 v[108:109], v11 offset:43008
    ds_read_b64_tr_b16 v[110:111], v11 offset:44032
    s_waitcnt lgkmcnt(4)
    v_mfma_f32_32x32x16_bf16 v[64:79], v[96:99], a[176:179], v[64:79]
    ds_read_b64_tr_b16 v[112:113], v10 offset:45056
    ds_read_b64_tr_b16 v[114:115], v10 offset:46080
    buffer_load_dwordx4 a[60:63], v2, s[16:19], s76 offen offset:3072 sc1
    s_add_u32 s76, s65, s71
    v_mfma_f32_32x32x16_bf16 v[80:95], v[100:103], a[176:179], v[80:95]
    ds_read_b64_tr_b16 v[116:117], v11 offset:45056
    ds_read_b64_tr_b16 v[118:119], v11 offset:46080
    buffer_load_dwordx4 a[64:67], v2, s[16:19], s76 offen offset:0 sc1
    s_waitcnt lgkmcnt(4)
    v_mfma_f32_32x32x16_bf16 v[64:79], v[104:107], a[180:183], v[64:79]
    ds_read_b64_tr_b16 v[120:121], v10 offset:47104
    ds_read_b64_tr_b16 v[122:123], v10 offset:48128
    v_mfma_f32_32x32x16_bf16 v[80:95], v[108:111], a[180:183], v[80:95]
    ds_read_b64_tr_b16 v[124:125], v11 offset:47104
    ds_read_b64_tr_b16 v[126:127], v11 offset:48128
    buffer_load_dwordx4 a[68:71], v2, s[16:19], s76 offen offset:1024 sc1
    s_waitcnt vmcnt(32)
    s_barrier
    s_waitcnt lgkmcnt(4)
    v_mfma_f32_32x32x16_bf16 v[64:79], v[112:115], a[184:187], v[64:79]
    ds_read_b64_tr_b16 v[96:97], v10 offset:49152
    ds_read_b64_tr_b16 v[98:99], v10 offset:50176
    buffer_load_dwordx4 a[72:75], v2, s[16:19], s76 offen offset:2048 sc1
    v_mfma_f32_32x32x16_bf16 v[80:95], v[116:119], a[184:187], v[80:95]
    ds_read_b64_tr_b16 v[100:101], v11 offset:49152
    ds_read_b64_tr_b16 v[102:103], v11 offset:50176
    s_waitcnt lgkmcnt(4)
    v_mfma_f32_32x32x16_bf16 v[64:79], v[120:123], a[188:191], v[64:79]
    ds_read_b64_tr_b16 v[104:105], v10 offset:51200
    ds_read_b64_tr_b16 v[106:107], v10 offset:52224
    buffer_load_dwordx4 a[76:79], v2, s[16:19], s76 offen offset:3072 sc1
    s_add_u32 s76, s66, s71
    v_mfma_f32_32x32x16_bf16 v[80:95], v[124:127], a[188:191], v[80:95]
    ds_read_b64_tr_b16 v[108:109], v11 offset:51200
    ds_read_b64_tr_b16 v[110:111], v11 offset:52224
    buffer_load_dwordx4 a[80:83], v2, s[16:19], s76 offen offset:0 sc1
    s_waitcnt lgkmcnt(4)
    v_mfma_f32_32x32x16_bf16 v[64:79], v[96:99], a[192:195], v[64:79]
    ds_read_b64_tr_b16 v[112:113], v10 offset:53248
    ds_read_b64_tr_b16 v[114:115], v10 offset:54272
    v_mfma_f32_32x32x16_bf16 v[80:95], v[100:103], a[192:195], v[80:95]
    ds_read_b64_tr_b16 v[116:117], v11 offset:53248
    ds_read_b64_tr_b16 v[118:119], v11 offset:54272
    buffer_load_dwordx4 a[84:87], v2, s[16:19], s76 offen offset:1024 sc1
    s_waitcnt lgkmcnt(4)
    v_mfma_f32_32x32x16_bf16 v[64:79], v[104:107], a[196:199], v[64:79]
    ds_read_b64_tr_b16 v[120:121], v10 offset:55296
    ds_read_b64_tr_b16 v[122:123], v10 offset:56320
    buffer_load_dwordx4 a[88:91], v2, s[16:19], s76 offen offset:2048 sc1
    v_mfma_f32_32x32x16_bf16 v[80:95], v[108:111], a[196:199], v[80:95]
    ds_read_b64_tr_b16 v[124:125], v11 offset:55296
    ds_read_b64_tr_b16 v[126:127], v11 offset:56320
    s_waitcnt lgkmcnt(4)
    v_mfma_f32_32x32x16_bf16 v[64:79], v[112:115], a[200:203], v[64:79]
    ds_read_b64_tr_b16 v[96:97], v10 offset:57344
    ds_read_b64_tr_b16 v[98:99], v10 offset:58368
    buffer_load_dwordx4 a[92:95], v2, s[16:19], s76 offen offset:3072 sc1
    s_add_u32 s76, s67, s71
    v_mfma_f32_32x32x16_bf16 v[80:95], v[116:119], a[200:203], v[80:95]
    ds_read_b64_tr_b16 v[100:101], v11 offset:57344
    ds_read_b64_tr_b16 v[102:103], v11 offset:58368
    buffer_load_dwordx4 a[96:99], v2, s[16:19], s76 offen offset:0 sc1
    s_waitcnt lgkmcnt(4)
    v_mfma_f32_32x32x16_bf16 v[64:79], v[120:123], a[204:207], v[64:79]
    ds_read_b64_tr_b16 v[104:105], v10 offset:59392
    ds_read_b64_tr_b16 v[106:107], v10 offset:60416
    v_mfma_f32_32x32x16_bf16 v[80:95], v[124:127], a[204:207], v[80:95]
    ds_read_b64_tr_b16 v[108:109], v11 offset:59392
    ds_read_b64_tr_b16 v[110:111], v11 offset:60416
    buffer_load_dwordx4 a[100:103], v2, s[16:19], s76 offen offset:1024 sc1
    s_waitcnt lgkmcnt(4)
    v_mfma_f32_32x32x16_bf16 v[64:79], v[96:99], a[208:211], v[64:79]
    ds_read_b64_tr_b16 v[112:113], v10 offset:61440
    ds_read_b64_tr_b16 v[114:115], v10 offset:62464
    buffer_load_dwordx4 a[104:107], v2, s[16:19], s76 offen offset:2048 sc1
    v_mfma_f32_32x32x16_bf16 v[80:95], v[100:103], a[208:211], v[80:95]
    ds_read_b64_tr_b16 v[116:117], v11 offset:61440
    ds_read_b64_tr_b16 v[118:119], v11 offset:62464
    s_waitcnt lgkmcnt(4)
    v_mfma_f32_32x32x16_bf16 v[64:79], v[104:107], a[212:215], v[64:79]
    ds_read_b64_tr_b16 v[120:121], v10 offset:63488
    ds_read_b64_tr_b16 v[122:123], v10 offset:64512
    buffer_load_dwordx4 a[108:111], v2, s[16:19], s76 offen offset:3072 sc1
    v_mfma_f32_32x32x16_bf16 v[80:95], v[108:111], a[212:215], v[80:95]
    ds_read_b64_tr_b16 v[124:125], v11 offset:63488
    ds_read_b64_tr_b16 v[126:127], v11 offset:64512
    s_waitcnt vmcnt(37)
    s_barrier
    s_waitcnt lgkmcnt(4)
    v_mfma_f32_32x32x16_bf16 v[64:79], v[112:115], a[216:219], v[64:79]
    ds_read_b64_tr_b16 v[96:97], v8 offset:0
    ds_read_b64_tr_b16 v[98:99], v8 offset:1024
    v_mfma_f32_32x32x16_bf16 v[80:95], v[116:119], a[216:219], v[80:95]
    ds_read_b64_tr_b16 v[100:101], v9 offset:0
    ds_read_b64_tr_b16 v[102:103], v9 offset:1024
    s_waitcnt lgkmcnt(4)
    v_mfma_f32_32x32x16_bf16 v[64:79], v[120:123], a[220:223], v[64:79]
    ds_read_b64_tr_b16 v[104:105], v8 offset:2048
    ds_read_b64_tr_b16 v[106:107], v8 offset:3072
    v_mfma_f32_32x32x16_bf16 v[80:95], v[124:127], a[220:223], v[80:95]
    ds_read_b64_tr_b16 v[108:109], v9 offset:2048
    ds_read_b64_tr_b16 v[110:111], v9 offset:3072
    s_add_u32 s35, s35, 1
    s_mov_b32 s68, s69
    s_add_u32 s69, s68, 128
    s_sub_u32 s75, s35, 1
    s_lshr_b32 s75, s75, 1
    s_mov_b32 s71, 0
    s_add_u32 s71, s71, 4096
    s_add_u32 s72, s60, s71
    s_waitcnt lgkmcnt(4)
    v_mfma_f32_32x32x16_bf16 v[32:47], v[96:99], v[128:131], v[32:47]
    ds_read_b64_tr_b16 v[112:113], v8 offset:4096
    ds_read_b64_tr_b16 v[114:115], v8 offset:5120
    v_lshlrev_b32 v192, 16, v176
    v_and_b32 v193, s79, v176
    v_lshlrev_b32 v194, 16, v144
    v_and_b32 v195, s79, v144
    v_fma_f32 v194, v192, v64, v194
    v_fma_f32 v195, v193, v65, v195
    v_cvt_pk_bf16_f32 v144, v194, v195
    v_lshlrev_b32 v196, 16, v177
    v_mfma_f32_32x32x16_bf16 v[48:63], v[100:103], v[128:131], v[48:63]
    ds_read_b64_tr_b16 v[116:117], v9 offset:4096
    ds_read_b64_tr_b16 v[118:119], v9 offset:5120
    s_add_u32 s83, s68, s55
    s_add_u32 m0, s70, 49152
    s_nop 0
    buffer_load_dwordx4 v4, s[8:11], s83 offen lds
    v_and_b32 v197, s79, v177
    v_lshlrev_b32 v198, 16, v145
    v_and_b32 v199, s79, v145
    v_fma_f32 v198, v196, v66, v198
    v_fma_f32 v199, v197, v67, v199
    v_cvt_pk_bf16_f32 v145, v198, v199
    v_lshlrev_b32 v200, 16, v178
    v_and_b32 v201, s79, v178
    s_waitcnt lgkmcnt(4)
    v_mfma_f32_32x32x16_bf16 v[32:47], v[104:107], v[132:135], v[32:47]
    ds_read_b64_tr_b16 v[120:121], v8 offset:6144
    ds_read_b64_tr_b16 v[122:123], v8 offset:7168
    v_lshlrev_b32 v202, 16, v146
    v_and_b32 v203, s79, v146
    v_fma_f32 v202, v200, v68, v202
    v_fma_f32 v203, v201, v69, v203
    v_cvt_pk_bf16_f32 v146, v202, v203
    v_lshlrev_b32 v204, 16, v179
    v_and_b32 v205, s79, v179
    v_lshlrev_b32 v206, 16, v147
    v_mfma_f32_32x32x16_bf16 v[48:63], v[108:111], v[132:135], v[48:63]
    ds_read_b64_tr_b16 v[124:125], v9 offset:6144
    ds_read_b64_tr_b16 v[126:127], v9 offset:7168
    buffer_load_dwordx4 v5, s[8:11], s83 offen offset:1024 lds
    v_and_b32 v207, s79, v147
    v_fma_f32 v206, v204, v70, v206
    v_fma_f32 v207, v205, v71, v207
    v_cvt_pk_bf16_f32 v147, v206, v207
    s_waitcnt lgkmcnt(4)
    v_mfma_f32_32x32x16_bf16 v[32:47], v[112:115], v[136:139], v[32:47]
    ds_read_b64_tr_b16 v[96:97], v8 offset:8192
    ds_read_b64_tr_b16 v[98:99], v8 offset:9216
    buffer_store_dwordx4 v[144:147], v2, s[16:19], s72 offen offset:0 sc1
    v_lshlrev_b32 v192, 16, v180
    v_and_b32 v193, s79, v180
    v_lshlrev_b32 v194, 16, v148
    v_and_b32 v195, s79, v148
    v_fma_f32 v194, v192, v72, v194
    v_fma_f32 v195, v193, v73, v195
    v_cvt_pk_bf16_f32 v148, v194, v195
    v_lshlrev_b32 v196, 16, v181
    v_mfma_f32_32x32x16_bf16 v[48:63], v[116:119], v[136:139], v[48:63]
    ds_read_b64_tr_b16 v[100:101], v9 offset:8192
    ds_read_b64_tr_b16 v[102:103], v9 offset:9216
    buffer_load_dwordx4 v6, s[8:11], s83 offen offset:2048 lds
    v_and_b32 v197, s79, v181
    v_lshlrev_b32 v198, 16, v149
    v_and_b32 v199, s79, v149
    v_fma_f32 v198, v196, v74, v198
    v_fma_f32 v199, v197, v75, v199
    v_cvt_pk_bf16_f32 v149, v198, v199
    v_lshlrev_b32 v200, 16, v182
    v_and_b32 v201, s79, v182
    s_waitcnt lgkmcnt(4)
    v_mfma_f32_32x32x16_bf16 v[32:47], v[120:123], v[140:143], v[32:47]
    ds_read_b64_tr_b16 v[104:105], v8 offset:10240
    ds_read_b64_tr_b16 v[106:107], v8 offset:11264
    v_lshlrev_b32 v202, 16, v150
    v_and_b32 v203, s79, v150
    v_fma_f32 v202, v200, v76, v202
    v_fma_f32 v203, v201, v77, v203
    v_cvt_pk_bf16_f32 v150, v202, v203
    v_lshlrev_b32 v204, 16, v183
    v_and_b32 v205, s79, v183
    v_lshlrev_b32 v206, 16, v151
    v_mfma_f32_32x32x16_bf16 v[48:63], v[124:127], v[140:143], v[48:63]
    ds_read_b64_tr_b16 v[108:109], v9 offset:10240
    ds_read_b64_tr_b16 v[110:111], v9 offset:11264
    buffer_load_dwordx4 v7, s[8:11], s83 offen offset:3072 lds
    v_and_b32 v207, s79, v151
    v_fma_f32 v206, v204, v78, v206
    v_fma_f32 v207, v205, v79, v207
    v_cvt_pk_bf16_f32 v151, v206, v207
    s_waitcnt vmcnt(32)
    s_waitcnt lgkmcnt(4)
    v_mfma_f32_32x32x16_bf16 v[32:47], v[96:99], a[0:3], v[32:47]
    ds_read_b64_tr_b16 v[112:113], v8 offset:12288
    ds_read_b64_tr_b16 v[114:115], v8 offset:13312
    buffer_store_dwordx4 v[148:151], v2, s[16:19], s72 offen offset:1024 sc1
    v_lshlrev_b32 v192, 16, v184
    v_and_b32 v193, s79, v184
    v_lshlrev_b32 v194, 16, v152
    v_and_b32 v195, s79, v152
    v_fma_f32 v194, v192, v80, v194
    v_fma_f32 v195, v193, v81, v195
    v_cvt_pk_bf16_f32 v152, v194, v195
    v_lshlrev_b32 v196, 16, v185
    v_mfma_f32_32x32x16_bf16 v[48:63], v[100:103], a[0:3], v[48:63]
    ds_read_b64_tr_b16 v[116:117], v9 offset:12288
    ds_read_b64_tr_b16 v[118:119], v9 offset:13312
    s_add_u32 s83, s68, s56
    s_add_u32 m0, s70, 65536
    s_nop 0
    buffer_load_dwordx4 v4, s[8:11], s83 offen lds
    v_and_b32 v197, s79, v185
    v_lshlrev_b32 v198, 16, v153
    v_and_b32 v199, s79, v153
    v_fma_f32 v198, v196, v82, v198
    v_fma_f32 v199, v197, v83, v199
    v_cvt_pk_bf16_f32 v153, v198, v199
    v_lshlrev_b32 v200, 16, v186
    v_and_b32 v201, s79, v186
    s_waitcnt vmcnt(33)
    s_waitcnt lgkmcnt(4)
    v_mfma_f32_32x32x16_bf16 v[32:47], v[104:107], a[4:7], v[32:47]
    ds_read_b64_tr_b16 v[120:121], v8 offset:14336
    ds_read_b64_tr_b16 v[122:123], v8 offset:15360
    v_lshlrev_b32 v202, 16, v154
    v_and_b32 v203, s79, v154
    v_fma_f32 v202, v200, v84, v202
    v_fma_f32 v203, v201, v85, v203
    v_cvt_pk_bf16_f32 v154, v202, v203
    v_lshlrev_b32 v204, 16, v187
    v_and_b32 v205, s79, v187
    v_lshlrev_b32 v206, 16, v155
    v_mfma_f32_32x32x16_bf16 v[48:63], v[108:111], a[4:7], v[48:63]
    ds_read_b64_tr_b16 v[124:125], v9 offset:14336
    ds_read_b64_tr_b16 v[126:127], v9 offset:15360
    buffer_load_dwordx4 v5, s[8:11], s83 offen offset:1024 lds
    v_and_b32 v207, s79, v155
    v_fma_f32 v206, v204, v86, v206
    v_fma_f32 v207, v205, v87, v207
    v_cvt_pk_bf16_f32 v155, v206, v207
    s_waitcnt vmcnt(40)
    s_barrier
    s_waitcnt vmcnt(33)
    s_waitcnt lgkmcnt(4)
    v_mfma_f32_32x32x16_bf16 v[32:47], v[112:115], a[8:11], v[32:47]
    ds_read_b64_tr_b16 v[96:97], v8 offset:16384
    ds_read_b64_tr_b16 v[98:99], v8 offset:17408
    buffer_store_dwordx4 v[152:155], v2, s[16:19], s72 offen offset:2048 sc1
    v_lshlrev_b32 v192, 16, v188
    v_and_b32 v193, s79, v188
    v_lshlrev_b32 v194, 16, v156
    v_and_b32 v195, s79, v156
    v_fma_f32 v194, v192, v88, v194
    v_fma_f32 v195, v193, v89, v195
    v_cvt_pk_bf16_f32 v156, v194, v195
    v_lshlrev_b32 v196, 16, v189
    v_mfma_f32_32x32x16_bf16 v[48:63], v[116:119], a[8:11], v[48:63]
    ds_read_b64_tr_b16 v[100:101], v9 offset:16384
    ds_read_b64_tr_b16 v[102:103], v9 offset:17408
    buffer_load_dwordx4 v6, s[8:11], s83 offen offset:2048 lds
    v_and_b32 v197, s79, v189
    v_lshlrev_b32 v198, 16, v157
    v_and_b32 v199, s79, v157
    v_fma_f32 v198, v196, v90, v198
    v_fma_f32 v199, v197, v91, v199
    v_cvt_pk_bf16_f32 v157, v198, v199
    v_lshlrev_b32 v200, 16, v190
    v_and_b32 v201, s79, v190
    s_waitcnt vmcnt(34)
    s_waitcnt lgkmcnt(4)
    v_mfma_f32_32x32x16_bf16 v[32:47], v[120:123], a[12:15], v[32:47]
    ds_read_b64_tr_b16 v[104:105], v8 offset:18432
    ds_read_b64_tr_b16 v[106:107], v8 offset:19456
    v_lshlrev_b32 v202, 16, v158
    v_and_b32 v203, s79, v158
    v_fma_f32 v202, v200, v92, v202
    v_fma_f32 v203, v201, v93, v203
    v_cvt_pk_bf16_f32 v158, v202, v203
    v_lshlrev_b32 v204, 16, v191
    v_and_b32 v205, s79, v191
    v_lshlrev_b32 v206, 16, v159
    v_mfma_f32_32x32x16_bf16 v[48:63], v[124:127], a[12:15], v[48:63]
    ds_read_b64_tr_b16 v[108:109], v9 offset:18432
    ds_read_b64_tr_b16 v[110:111], v9 offset:19456
    buffer_load_dwordx4 v7, s[8:11], s83 offen offset:3072 lds
    v_and_b32 v207, s79, v159
    v_fma_f32 v206, v204, v94, v206
    v_fma_f32 v207, v205, v95, v207
    v_cvt_pk_bf16_f32 v159, v206, v207
    s_waitcnt vmcnt(34)
    s_waitcnt lgkmcnt(4)
    v_mfma_f32_32x32x16_bf16 v[32:47], v[96:99], a[16:19], v[32:47]
    ds_read_b64_tr_b16 v[112:113], v8 offset:20480
    ds_read_b64_tr_b16 v[114:115], v8 offset:21504
    buffer_store_dwordx4 v[156:159], v2, s[16:19], s72 offen offset:3072 sc1
    v_mfma_f32_32x32x16_bf16 v[48:63], v[100:103], a[16:19], v[48:63]
    ds_read_b64_tr_b16 v[116:117], v9 offset:20480
    ds_read_b64_tr_b16 v[118:119], v9 offset:21504
    s_add_u32 s83, s68, s57
    s_add_u32 m0, s70, 81920
    s_nop 0
    buffer_load_dwordx4 v4, s[8:11], s83 offen lds
    s_waitcnt vmcnt(35)
    s_waitcnt lgkmcnt(4)
    v_mfma_f32_32x32x16_bf16 v[32:47], v[104:107], a[20:23], v[32:47]
    ds_read_b64_tr_b16 v[120:121], v8 offset:22528
    ds_read_b64_tr_b16 v[122:123], v8 offset:23552
    v_mfma_f32_32x32x16_bf16 v[48:63], v[108:111], a[20:23], v[48:63]
    ds_read_b64_tr_b16 v[124:125], v9 offset:22528
    ds_read_b64_tr_b16 v[126:127], v9 offset:23552
    buffer_load_dwordx4 v5, s[8:11], s83 offen offset:1024 lds
    v_add_u32 v12, 256, v12
    ds_read_b128 v[64:67], v12 offset:0
    ds_read_b128 v[68:71], v12 offset:32
    ds_read_b128 v[72:75], v12 offset:64
    ds_read_b128 v[76:79], v12 offset:96
    ds_read_b128 v[80:83], v12 offset:128
    ds_read_b128 v[84:87], v12 offset:160
    ds_read_b128 v[88:91], v12 offset:192
    ds_read_b128 v[92:95], v12 offset:224
    s_waitcnt vmcnt(35)
    s_waitcnt lgkmcnt(4)
    v_mfma_f32_32x32x16_bf16 v[32:47], v[112:115], a[24:27], v[32:47]
    ds_read_b64_tr_b16 v[96:97], v8 offset:24576
    ds_read_b64_tr_b16 v[98:99], v8 offset:25600
    v_mfma_f32_32x32x16_bf16 v[48:63], v[116:119], a[24:27], v[48:63]
    ds_read_b64_tr_b16 v[100:101], v9 offset:24576
    ds_read_b64_tr_b16 v[102:103], v9 offset:25600
    buffer_load_dwordx4 v6, s[8:11], s83 offen offset:2048 lds
    s_waitcnt vmcnt(35)
    s_waitcnt lgkmcnt(4)
    v_mfma_f32_32x32x16_bf16 v[32:47], v[120:123], a[28:31], v[32:47]
    ds_read_b64_tr_b16 v[104:105], v8 offset:26624
    ds_read_b64_tr_b16 v[106:107], v8 offset:27648
    v_mov_b32 v16, s35
    s_waitcnt vmcnt(3)
    buffer_store_dword v16, v15, s[16:19], s73 offen sc1
    v_mfma_f32_32x32x16_bf16 v[48:63], v[124:127], a[28:31], v[48:63]
    ds_read_b64_tr_b16 v[108:109], v9 offset:26624
    ds_read_b64_tr_b16 v[110:111], v9 offset:27648
    buffer_load_dwordx4 v7, s[8:11], s83 offen offset:3072 lds
    s_waitcnt vmcnt(36)
    s_waitcnt lgkmcnt(4)
    v_mfma_f32_32x32x16_bf16 v[32:47], v[96:99], a[32:35], v[32:47]
    ds_read_b64_tr_b16 v[112:113], v8 offset:28672
    ds_read_b64_tr_b16 v[114:115], v8 offset:29696
    v_mfma_f32_32x32x16_bf16 v[48:63], v[100:103], a[32:35], v[48:63]
    ds_read_b64_tr_b16 v[116:117], v9 offset:28672
    ds_read_b64_tr_b16 v[118:119], v9 offset:29696
    s_add_u32 s83, s68, s58
    s_add_u32 m0, s70, 98304
    s_nop 0
    buffer_load_dwordx4 v4, s[8:11], s83 offen lds
    s_waitcnt vmcnt(36)
    s_waitcnt lgkmcnt(4)
    v_mfma_f32_32x32x16_bf16 v[32:47], v[104:107], a[36:39], v[32:47]
    ds_read_b64_tr_b16 v[120:121], v8 offset:30720
    ds_read_b64_tr_b16 v[122:123], v8 offset:31744
    v_mfma_f32_32x32x16_bf16 v[48:63], v[108:111], a[36:39], v[48:63]
    ds_read_b64_tr_b16 v[124:125], v9 offset:30720
    ds_read_b64_tr_b16 v[126:127], v9 offset:31744
    buffer_load_dwordx4 v5, s[8:11], s83 offen offset:1024 lds
    s_waitcnt vmcnt(47)
    s_barrier
    s_waitcnt vmcnt(36)
    s_waitcnt lgkmcnt(4)
    v_mfma_f32_32x32x16_bf16 v[32:47], v[112:115], a[40:43], v[32:47]
    ds_read_b64_tr_b16 v[96:97], v8 offset:32768
    ds_read_b64_tr_b16 v[98:99], v8 offset:33792
    v_mfma_f32_32x32x16_bf16 v[48:63], v[116:119], a[40:43], v[48:63]
    ds_read_b64_tr_b16 v[100:101], v9 offset:32768
    ds_read_b64_tr_b16 v[102:103], v9 offset:33792
    buffer_load_dwordx4 v6, s[8:11], s83 offen offset:2048 lds
    s_waitcnt vmcnt(36)
    s_waitcnt lgkmcnt(4)
    v_mfma_f32_32x32x16_bf16 v[32:47], v[120:123], a[44:47], v[32:47]
    ds_read_b64_tr_b16 v[104:105], v8 offset:34816
    ds_read_b64_tr_b16 v[106:107], v8 offset:35840
    v_mfma_f32_32x32x16_bf16 v[48:63], v[124:127], a[44:47], v[48:63]
    ds_read_b64_tr_b16 v[108:109], v9 offset:34816
    ds_read_b64_tr_b16 v[110:111], v9 offset:35840
    buffer_load_dwordx4 v7, s[8:11], s83 offen offset:3072 lds
    s_waitcnt vmcnt(36)
    s_waitcnt lgkmcnt(4)
    v_mfma_f32_32x32x16_bf16 v[32:47], v[96:99], a[48:51], v[32:47]
    ds_read_b64_tr_b16 v[112:113], v8 offset:36864
    ds_read_b64_tr_b16 v[114:115], v8 offset:37888
    s_load_dwordx8 s[40:47], s[50:51], s82 glc
    v_mfma_f32_32x32x16_bf16 v[48:63], v[100:103], a[48:51], v[48:63]
    ds_read_b64_tr_b16 v[116:117], v9 offset:36864
    ds_read_b64_tr_b16 v[118:119], v9 offset:37888
    s_add_u32 s83, s68, s59
    s_add_u32 m0, s70, 114688
    s_nop 0
    buffer_load_dwordx4 v4, s[8:11], s83 offen lds
    s_waitcnt vmcnt(36)
    s_waitcnt lgkmcnt(4)
    v_mfma_f32_32x32x16_bf16 v[32:47], v[104:107], a[52:55], v[32:47]
    ds_read_b64_tr_b16 v[120:121], v8 offset:38912
    ds_read_b64_tr_b16 v[122:123], v8 offset:39936
    v_mfma_f32_32x32x16_bf16 v[48:63], v[108:111], a[52:55], v[48:63]
    ds_read_b64_tr_b16 v[124:125], v9 offset:38912
    ds_read_b64_tr_b16 v[126:127], v9 offset:39936
    buffer_load_dwordx4 v5, s[8:11], s83 offen offset:1024 lds
    s_waitcnt vmcnt(36)
    s_waitcnt lgkmcnt(4)
    v_mfma_f32_32x32x16_bf16 v[32:47], v[112:115], a[56:59], v[32:47]
    ds_read_b64_tr_b16 v[96:97], v8 offset:40960
    ds_read_b64_tr_b16 v[98:99], v8 offset:41984
    v_mfma_f32_32x32x16_bf16 v[48:63], v[116:119], a[56:59], v[48:63]
    ds_read_b64_tr_b16 v[100:101], v9 offset:40960
    ds_read_b64_tr_b16 v[102:103], v9 offset:41984
    buffer_load_dwordx4 v6, s[8:11], s83 offen offset:2048 lds
    s_waitcnt vmcnt(36)
    s_waitcnt lgkmcnt(4)
    v_mfma_f32_32x32x16_bf16 v[32:47], v[120:123], a[60:63], v[32:47]
    ds_read_b64_tr_b16 v[104:105], v8 offset:43008
    ds_read_b64_tr_b16 v[106:107], v8 offset:44032
    v_mfma_f32_32x32x16_bf16 v[48:63], v[124:127], a[60:63], v[48:63]
    ds_read_b64_tr_b16 v[108:109], v9 offset:43008
    ds_read_b64_tr_b16 v[110:111], v9 offset:44032
    buffer_load_dwordx4 v7, s[8:11], s83 offen offset:3072 lds
    s_waitcnt vmcnt(36)
    s_waitcnt lgkmcnt(4)
    v_mfma_f32_32x32x16_bf16 v[32:47], v[96:99], a[64:67], v[32:47]
    ds_read_b64_tr_b16 v[112:113], v8 offset:45056
    ds_read_b64_tr_b16 v[114:115], v8 offset:46080
    s_waitcnt lgkmcnt(0)
    s_min_u32 s40, s40, s41
    s_min_u32 s42, s42, s43
    s_min_u32 s44, s44, s45
    s_min_u32 s46, s46, s47
    s_min_u32 s40, s40, s42
    s_min_u32 s44, s44, s46
    s_min_u32 s40, s40, s44
    s_cmp_ge_u32 s40, s35
    s_cbranch_scc0 Lslow_11
Lpok_6:
    v_mfma_f32_32x32x16_bf16 v[48:63], v[100:103], a[64:67], v[48:63]
    ds_read_b64_tr_b16 v[116:117], v9 offset:45056
    ds_read_b64_tr_b16 v[118:119], v9 offset:46080
    s_add_u32 s76, s61, s71
    buffer_load_dwordx4 a[112:115], v2, s[16:19], s76 offen offset:0 sc1
    s_waitcnt vmcnt(36)
    s_waitcnt lgkmcnt(4)
    v_mfma_f32_32x32x16_bf16 v[32:47], v[104:107], a[68:71], v[32:47]
    ds_read_b64_tr_b16 v[120:121], v8 offset:47104
    ds_read_b64_tr_b16 v[122:123], v8 offset:48128
    v_mfma_f32_32x32x16_bf16 v[48:63], v[108:111], a[68:71], v[48:63]
    ds_read_b64_tr_b16 v[124:125], v9 offset:47104
    ds_read_b64_tr_b16 v[126:127], v9 offset:48128
    buffer_load_dwordx4 a[116:119], v2, s[16:19], s76 offen offset:1024 sc1
    s_waitcnt vmcnt(22)
    s_barrier
    s_waitcnt vmcnt(36)
    s_waitcnt lgkmcnt(4)
    v_mfma_f32_32x32x16_bf16 v[32:47], v[112:115], a[72:75], v[32:47]
    ds_read_b64_tr_b16 v[96:97], v8 offset:49152
    ds_read_b64_tr_b16 v[98:99], v8 offset:50176
    buffer_load_dwordx4 a[120:123], v2, s[16:19], s76 offen offset:2048 sc1
    v_mfma_f32_32x32x16_bf16 v[48:63], v[116:119], a[72:75], v[48:63]
    ds_read_b64_tr_b16 v[100:101], v9 offset:49152
    ds_read_b64_tr_b16 v[102:103], v9 offset:50176
    s_waitcnt vmcnt(36)
    s_waitcnt lgkmcnt(4)
    v_mfma_f32_32x32x16_bf16 v[32:47], v[120:123], a[76:79], v[32:47]
    ds_read_b64_tr_b16 v[104:105], v8 offset:51200
    ds_read_b64_tr_b16 v[106:107], v8 offset:52224
    buffer_load_dwordx4 a[124:127], v2, s[16:19], s76 offen offset:3072 sc1
    s_add_u32 s76, s62, s71
    v_mfma_f32_32x32x16_bf16 v[48:63], v[124:127], a[76:79], v[48:63]
    ds_read_b64_tr_b16 v[108:109], v9 offset:51200
    ds_read_b64_tr_b16 v[110:111], v9 offset:52224
    buffer_load_dwordx4 a[128:131], v2, s[16:19], s76 offen offset:0 sc1
    s_waitcnt vmcnt(37)
    s_waitcnt lgkmcnt(4)
    v_mfma_f32_32x32x16_bf16 v[32:47], v[96:99], a[80:83], v[32:47]
    ds_read_b64_tr_b16 v[112:113], v8 offset:53248
    ds_read_b64_tr_b16 v[114:115], v8 offset:54272
    v_mfma_f32_32x32x16_bf16 v[48:63], v[100:103], a[80:83], v[48:63]
    ds_read_b64_tr_b16 v[116:117], v9 offset:53248
    ds_read_b64_tr_b16 v[118:119], v9 offset:54272
    buffer_load_dwordx4 a[132:135], v2, s[16:19], s76 offen offset:1024 sc1
    s_waitcnt vmcnt(37)
    s_waitcnt lgkmcnt(4)
    v_mfma_f32_32x32x16_bf16 v[32:47], v[104:107], a[84:87], v[32:47]
    ds_read_b64_tr_b16 v[120:121], v8 offset:55296
    ds_read_b64_tr_b16 v[122:123], v8 offset:56320
    buffer_load_dwordx4 a[136:139], v2, s[16:19], s76 offen offset:2048 sc1
    v_mfma_f32_32x32x16_bf16 v[48:63], v[108:111], a[84:87], v[48:63]
    ds_read_b64_tr_b16 v[124:125], v9 offset:55296
    ds_read_b64_tr_b16 v[126:127], v9 offset:56320
    s_waitcnt vmcnt(37)
    s_waitcnt lgkmcnt(4)
    v_mfma_f32_32x32x16_bf16 v[32:47], v[112:115], a[88:91], v[32:47]
    ds_read_b64_tr_b16 v[96:97], v8 offset:57344
    ds_read_b64_tr_b16 v[98:99], v8 offset:58368
    buffer_load_dwordx4 a[140:143], v2, s[16:19], s76 offen offset:3072 sc1
    s_add_u32 s76, s63, s71
    v_mfma_f32_32x32x16_bf16 v[48:63], v[116:119], a[88:91], v[48:63]
    ds_read_b64_tr_b16 v[100:101], v9 offset:57344
    ds_read_b64_tr_b16 v[102:103], v9 offset:58368
    buffer_load_dwordx4 a[144:147], v2, s[16:19], s76 offen offset:0 sc1
    s_waitcnt vmcnt(38)
    s_waitcnt lgkmcnt(4)
    v_mfma_f32_32x32x16_bf16 v[32:47], v[120:123], a[92:95], v[32:47]
    ds_read_b64_tr_b16 v[104:105], v8 offset:59392
    ds_read_b64_tr_b16 v[106:107], v8 offset:60416
    v_mfma_f32_32x32x16_bf16 v[48:63], v[124:127], a[92:95], v[48:63]
    ds_read_b64_tr_b16 v[108:109], v9 offset:59392
    ds_read_b64_tr_b16 v[110:111], v9 offset:60416
    buffer_load_dwordx4 a[148:151], v2, s[16:19], s76 offen offset:1024 sc1
    s_waitcnt vmcnt(38)
    s_waitcnt lgkmcnt(4)
    v_mfma_f32_32x32x16_bf16 v[32:47], v[96:99], a[96:99], v[32:47]
    ds_read_b64_tr_b16 v[112:113], v8 offset:61440
    ds_read_b64_tr_b16 v[114:115], v8 offset:62464
    buffer_load_dwordx4 a[152:155], v2, s[16:19], s76 offen offset:2048 sc1
    v_mfma_f32_32x32x16_bf16 v[48:63], v[100:103], a[96:99], v[48:63]
    ds_read_b64_tr_b16 v[116:117], v9 offset:61440
    ds_read_b64_tr_b16 v[118:119], v9 offset:62464
    s_waitcnt vmcnt(38)
    s_waitcnt lgkmcnt(4)
    v_mfma_f32_32x32x16_bf16 v[32:47], v[104:107], a[100:103], v[32:47]
    ds_read_b64_tr_b16 v[120:121], v8 offset:63488
    ds_read_b64_tr_b16 v[122:123], v8 offset:64512
    buffer_load_dwordx4 a[156:159], v2, s[16:19], s76 offen offset:3072 sc1
    s_add_u32 s76, s64, s71
    v_mfma_f32_32x32x16_bf16 v[48:63], v[108:111], a[100:103], v[48:63]
    ds_read_b64_tr_b16 v[124:125], v9 offset:63488
    ds_read_b64_tr_b16 v[126:127], v9 offset:64512
    buffer_load_dwordx4 a[160:163], v2, s[16:19], s76 offen offset:0 sc1
    s_waitcnt vmcnt(27)
    s_barrier
    s_waitcnt vmcnt(39)
    s_waitcnt lgkmcnt(4)
    v_mfma_f32_32x32x16_bf16 v[32:47], v[112:115], a[104:107], v[32:47]
    ds_read_b64_tr_b16 v[96:97], v10 offset:0
    ds_read_b64_tr_b16 v[98:99], v10 offset:1024
    v_mfma_f32_32x32x16_bf16 v[48:63], v[116:119], a[104:107], v[48:63]
    ds_read_b64_tr_b16 v[100:101], v11 offset:0
    ds_read_b64_tr_b16 v[102:103], v11 offset:1024
    buffer_load_dwordx4 a[164:167], v2, s[16:19], s76 offen offset:1024 sc1
    s_waitcnt vmcnt(39)
    s_waitcnt lgkmcnt(4)
    v_mfma_f32_32x32x16_bf16 v[32:47], v[120:123], a[108:111], v[32:47]
    ds_read_b64_tr_b16 v[104:105], v10 offset:2048
    ds_read_b64_tr_b16 v[106:107], v10 offset:3072
    buffer_load_dwordx4 a[168:171], v2, s[16:19], s76 offen offset:2048 sc1
    v_mfma_f32_32x32x16_bf16 v[48:63], v[124:127], a[108:111], v[48:63]
    ds_read_b64_tr_b16 v[108:109], v11 offset:2048
    ds_read_b64_tr_b16 v[110:111], v11 offset:3072
    s_waitcnt lgkmcnt(4)
    v_mfma_f32_32x32x16_bf16 v[32:47], v[96:99], v[144:147], v[32:47]
    ds_read_b64_tr_b16 v[112:113], v10 offset:4096
    ds_read_b64_tr_b16 v[114:115], v10 offset:5120
    buffer_load_dwordx4 a[172:175], v2, s[16:19], s76 offen offset:3072 sc1
    s_add_u32 s76, s65, s71
    v_mfma_f32_32x32x16_bf16 v[48:63], v[100:103], v[144:147], v[48:63]
    ds_read_b64_tr_b16 v[116:117], v11 offset:4096
    ds_read_b64_tr_b16 v[118:119], v11 offset:5120
    buffer_load_dwordx4 a[176:179], v2, s[16:19], s76 offen offset:0 sc1
    s_waitcnt lgkmcnt(4)
    v_mfma_f32_32x32x16_bf16 v[32:47], v[104:107], v[148:151], v[32:47]
    ds_read_b64_tr_b16 v[120:121], v10 offset:6144
    ds_read_b64_tr_b16 v[122:123], v10 offset:7168
    v_mfma_f32_32x32x16_bf16 v[48:63], v[108:111], v[148:151], v[48:63]
    ds_read_b64_tr_b16 v[124:125], v11 offset:6144
    ds_read_b64_tr_b16 v[126:127], v11 offset:7168
    buffer_load_dwordx4 a[180:183], v2, s[16:19], s76 offen offset:1024 sc1
    s_waitcnt lgkmcnt(4)
    v_mfma_f32_32x32x16_bf16 v[32:47], v[112:115], v[152:155], v[32:47]
    ds_read_b64_tr_b16 v[96:97], v10 offset:8192
    ds_read_b64_tr_b16 v[98:99], v10 offset:9216
    buffer_load_dwordx4 a[184:187], v2, s[16:19], s76 offen offset:2048 sc1
    v_mfma_f32_32x32x16_bf16 v[48:63], v[116:119], v[152:155], v[48:63]
    ds_read_b64_tr_b16 v[100:101], v11 offset:8192
    ds_read_b64_tr_b16 v[102:103], v11 offset:9216
    s_waitcnt lgkmcnt(4)
    v_mfma_f32_32x32x16_bf16 v[32:47], v[120:123], v[156:159], v[32:47]
    ds_read_b64_tr_b16 v[104:105], v10 offset:10240
    ds_read_b64_tr_b16 v[106:107], v10 offset:11264
    buffer_load_dwordx4 a[188:191], v2, s[16:19], s76 offen offset:3072 sc1
    s_add_u32 s76, s66, s71
    v_mfma_f32_32x32x16_bf16 v[48:63], v[124:127], v[156:159], v[48:63]
    ds_read_b64_tr_b16 v[108:109], v11 offset:10240
    ds_read_b64_tr_b16 v[110:111], v11 offset:11264
    buffer_load_dwordx4 a[192:195], v2, s[16:19], s76 offen offset:0 sc1
    s_waitcnt vmcnt(20)
    s_waitcnt lgkmcnt(4)
    v_mfma_f32_32x32x16_bf16 v[32:47], v[96:99], a[112:115], v[32:47]
    ds_read_b64_tr_b16 v[112:113], v10 offset:12288
    ds_read_b64_tr_b16 v[114:115], v10 offset:13312
    v_mfma_f32_32x32x16_bf16 v[48:63], v[100:103], a[112:115], v[48:63]
    ds_read_b64_tr_b16 v[116:117], v11 offset:12288
    ds_read_b64_tr_b16 v[118:119], v11 offset:13312
    buffer_load_dwordx4 a[196:199], v2, s[16:19], s76 offen offset:1024 sc1
    s_waitcnt vmcnt(20)
    s_waitcnt lgkmcnt(4)
    v_mfma_f32_32x32x16_bf16 v[32:47], v[104:107], a[116:119], v[32:47]
    ds_read_b64_tr_b16 v[120:121], v10 offset:14336
    ds_read_b64_tr_b16 v[122:123], v10 offset:15360
    buffer_load_dwordx4 a[200:203], v2, s[16:19], s76 offen offset:2048 sc1
    v_mfma_f32_32x32x16_bf16 v[48:63], v[108:111], a[116:119], v[48:63]
    ds_read_b64_tr_b16 v[124:125], v11 offset:14336
    ds_read_b64_tr_b16 v[126:127], v11 offset:15360
    s_waitcnt vmcnt(31)
    s_barrier
    s_waitcnt vmcnt(20)
    s_waitcnt lgkmcnt(4)
    v_mfma_f32_32x32x16_bf16 v[32:47], v[112:115], a[120:123], v[32:47]
    ds_read_b64_tr_b16 v[96:97], v10 offset:16384
    ds_read_b64_tr_b16 v[98:99], v10 offset:17408
    buffer_load_dwordx4 a[204:207], v2, s[16:19], s76 offen offset:3072 sc1
    s_add_u32 s76, s67, s71
    v_mfma_f32_32x32x16_bf16 v[48:63], v[116:119], a[120:123], v[48:63]
    ds_read_b64_tr_b16 v[100:101], v11 offset:16384
    ds_read_b64_tr_b16 v[102:103], v11 offset:17408
    buffer_load_dwordx4 a[208:211], v2, s[16:19], s76 offen offset:0 sc1
    s_waitcnt vmcnt(21)
    s_waitcnt lgkmcnt(4)
    v_mfma_f32_32x32x16_bf16 v[32:47], v[120:123], a[124:127], v[32:47]
    ds_read_b64_tr_b16 v[104:105], v10 offset:18432
    ds_read_b64_tr_b16 v[106:107], v10 offset:19456
    v_mfma_f32_32x32x16_bf16 v[48:63], v[124:127], a[124:127], v[48:63]
    ds_read_b64_tr_b16 v[108:109], v11 offset:18432
    ds_read_b64_tr_b16 v[110:111], v11 offset:19456
    buffer_load_dwordx4 a[212:215], v2, s[16:19], s76 offen offset:1024 sc1
    s_waitcnt vmcnt(21)
    s_waitcnt lgkmcnt(4)
    v_mfma_f32_32x32x16_bf16 v[32:47], v[96:99], a[128:131], v[32:47]
    ds_read_b64_tr_b16 v[112:113], v10 offset:20480
    ds_read_b64_tr_b16 v[114:115], v10 offset:21504
    buffer_load_dwordx4 a[216:219], v2, s[16:19], s76 offen offset:2048 sc1
    v_mfma_f32_32x32x16_bf16 v[48:63], v[100:103], a[128:131], v[48:63]
    ds_read_b64_tr_b16 v[116:117], v11 offset:20480
    ds_read_b64_tr_b16 v[118:119], v11 offset:21504
    s_waitcnt vmcnt(21)
    s_waitcnt lgkmcnt(4)
    v_mfma_f32_32x32x16_bf16 v[32:47], v[104:107], a[132:135], v[32:47]
    ds_read_b64_tr_b16 v[120:121], v10 offset:22528
    ds_read_b64_tr_b16 v[122:123], v10 offset:23552
    buffer_load_dwordx4 a[220:223], v2, s[16:19], s76 offen offset:3072 sc1
    v_mfma_f32_32x32x16_bf16 v[48:63], v[108:111], a[132:135], v[48:63]
    ds_read_b64_tr_b16 v[124:125], v11 offset:22528
    ds_read_b64_tr_b16 v[126:127], v11 offset:23552
    s_waitcnt vmcnt(21)
    s_waitcnt lgkmcnt(4)
    v_mfma_f32_32x32x16_bf16 v[32:47], v[112:115], a[136:139], v[32:47]
    ds_read_b64_tr_b16 v[96:97], v10 offset:24576
    ds_read_b64_tr_b16 v[98:99], v10 offset:25600
    v_mfma_f32_32x32x16_bf16 v[48:63], v[116:119], a[136:139], v[48:63]
    ds_read_b64_tr_b16 v[100:101], v11 offset:24576
    ds_read_b64_tr_b16 v[102:103], v11 offset:25600
    s_waitcnt vmcnt(20)
    s_waitcnt lgkmcnt(4)
    v_mfma_f32_32x32x16_bf16 v[32:47], v[120:123], a[140:143], v[32:47]
    ds_read_b64_tr_b16 v[104:105], v10 offset:26624
    ds_read_b64_tr_b16 v[106:107], v10 offset:27648
    s_add_u32 s83, s69, s52
    s_add_u32 m0, s70, 0
    s_nop 0
    buffer_load_dwordx4 v4, s[8:11], s83 offen lds
    v_mfma_f32_32x32x16_bf16 v[48:63], v[124:127], a[140:143], v[48:63]
    ds_read_b64_tr_b16 v[108:109], v11 offset:26624
    ds_read_b64_tr_b16 v[110:111], v11 offset:27648
    s_waitcnt vmcnt(20)
    s_waitcnt lgkmcnt(4)
    v_mfma_f32_32x32x16_bf16 v[32:47], v[96:99], a[144:147], v[32:47]
    ds_read_b64_tr_b16 v[112:113], v10 offset:28672
    ds_read_b64_tr_b16 v[114:115], v10 offset:29696
    v_mfma_f32_32x32x16_bf16 v[48:63], v[100:103], a[144:147], v[48:63]
    ds_read_b64_tr_b16 v[116:117], v11 offset:28672
    ds_read_b64_tr_b16 v[118:119], v11 offset:29696
    buffer_load_dwordx4 v5, s[8:11], s83 offen offset:1024 lds
    s_waitcnt vmcnt(20)
    s_waitcnt lgkmcnt(4)
    v_mfma_f32_32x32x16_bf16 v[32:47], v[104:107], a[148:151], v[32:47]
    ds_read_b64_tr_b16 v[120:121], v10 offset:30720
    ds_read_b64_tr_b16 v[122:123], v10 offset:31744
    v_mfma_f32_32x32x16_bf16 v[48:63], v[108:111], a[148:151], v[48:63]
    ds_read_b64_tr_b16 v[124:125], v11 offset:30720
    ds_read_b64_tr_b16 v[126:127], v11 offset:31744
    s_waitcnt vmcnt(34)
    s_barrier
    s_waitcnt vmcnt(19)
    s_waitcnt lgkmcnt(4)
    v_mfma_f32_32x32x16_bf16 v[32:47], v[112:115], a[152:155], v[32:47]
    ds_read_b64_tr_b16 v[96:97], v10 offset:32768
    ds_read_b64_tr_b16 v[98:99], v10 offset:33792
    buffer_load_dwordx4 v6, s[8:11], s83 offen offset:2048 lds
    v_mfma_f32_32x32x16_bf16 v[48:63], v[116:119], a[152:155], v[48:63]
    ds_read_b64_tr_b16 v[100:101], v11 offset:32768
    ds_read_b64_tr_b16 v[102:103], v11 offset:33792
    s_waitcnt vmcnt(19)
    s_waitcnt lgkmcnt(4)
    v_mfma_f32_32x32x16_bf16 v[32:47], v[120:123], a[156:159], v[32:47]
    ds_read_b64_tr_b16 v[104:105], v10 offset:34816
    ds_read_b64_tr_b16 v[106:107], v10 offset:35840
    v_mfma_f32_32x32x16_bf16 v[48:63], v[124:127], a[156:159], v[48:63]
    ds_read_b64_tr_b16 v[108:109], v11 offset:34816
    ds_read_b64_tr_b16 v[110:111], v11 offset:35840
    buffer_load_dwordx4 v7, s[8:11], s83 offen offset:3072 lds
    s_waitcnt vmcnt(19)
    s_waitcnt lgkmcnt(4)
    v_mfma_f32_32x32x16_bf16 v[32:47], v[96:99], a[160:163], v[32:47]
    ds_read_b64_tr_b16 v[112:113], v10 offset:36864
    ds_read_b64_tr_b16 v[114:115], v10 offset:37888
    v_mfma_f32_32x32x16_bf16 v[48:63], v[100:103], a[160:163], v[48:63]
    ds_read_b64_tr_b16 v[116:117], v11 offset:36864
    ds_read_b64_tr_b16 v[118:119], v11 offset:37888
    s_waitcnt vmcnt(18)
    s_waitcnt lgkmcnt(4)
    v_mfma_f32_32x32x16_bf16 v[32:47], v[104:107], a[164:167], v[32:47]
    ds_read_b64_tr_b16 v[120:121], v10 offset:38912
    ds_read_b64_tr_b16 v[122:123], v10 offset:39936
    s_add_u32 s83, s69, s53
    s_add_u32 m0, s70, 16384
    s_nop 0
    buffer_load_dwordx4 v4, s[8:11], s83 offen lds
    v_mfma_f32_32x32x16_bf16 v[48:63], v[108:111], a[164:167], v[48:63]
    ds_read_b64_tr_b16 v[124:125], v11 offset:38912
    ds_read_b64_tr_b16 v[126:127], v11 offset:39936
    s_waitcnt vmcnt(18)
    s_waitcnt lgkmcnt(4)
    v_mfma_f32_32x32x16_bf16 v[32:47], v[112:115], a[168:171], v[32:47]
    ds_read_b64_tr_b16 v[96:97], v10 offset:40960
    ds_read_b64_tr_b16 v[98:99], v10 offset:41984
    v_mfma_f32_32x32x16_bf16 v[48:63], v[116:119], a[168:171], v[48:63]
    ds_read_b64_tr_b16 v[100:101], v11 offset:40960
    ds_read_b64_tr_b16 v[102:103], v11 offset:41984
    buffer_load_dwordx4 v5, s[8:11], s83 offen offset:1024 lds
    s_waitcnt vmcnt(18)
    s_waitcnt lgkmcnt(4)
    v_mfma_f32_32x32x16_bf16 v[32:47], v[120:123], a[172:175], v[32:47]
    ds_read_b64_tr_b16 v[104:105], v10 offset:43008
    ds_read_b64_tr_b16 v[106:107], v10 offset:44032
    v_mfma_f32_32x32x16_bf16 v[48:63], v[124:127], a[172:175], v[48:63]
    ds_read_b64_tr_b16 v[108:109], v11 offset:43008
    ds_read_b64_tr_b16 v[110:111], v11 offset:44032
    s_waitcnt vmcnt(17)
    s_waitcnt lgkmcnt(4)
    v_mfma_f32_32x32x16_bf16 v[32:47], v[96:99], a[176:179], v[32:47]
    ds_read_b64_tr_b16 v[112:113], v10 offset:45056
    ds_read_b64_tr_b16 v[114:115], v10 offset:46080
    buffer_load_dwordx4 v6, s[8:11], s83 offen offset:2048 lds
    v_mfma_f32_32x32x16_bf16 v[48:63], v[100:103], a[176:179], v[48:63]
    ds_read_b64_tr_b16 v[116:117], v11 offset:45056
    ds_read_b64_tr_b16 v[118:119], v11 offset:46080
    s_waitcnt vmcnt(17)
    s_waitcnt lgkmcnt(4)
    v_mfma_f32_32x32x16_bf16 v[32:47], v[104:107], a[180:183], v[32:47]
    ds_read_b64_tr_b16 v[120:121], v10 offset:47104
    ds_read_b64_tr_b16 v[122:123], v10 offset:48128
    v_mfma_f32_32x32x16_bf16 v[48:63], v[108:111], a[180:183], v[48:63]
    ds_read_b64_tr_b16 v[124:125], v11 offset:47104
    ds_read_b64_tr_b16 v[126:127], v11 offset:48128
    buffer_load_dwordx4 v7, s[8:11], s83 offen offset:3072 lds
    s_waitcnt vmcnt(36)
    s_barrier
    s_waitcnt vmcnt(17)
    s_waitcnt lgkmcnt(4)
    v_mfma_f32_32x32x16_bf16 v[32:47], v[112:115], a[184:187], v[32:47]
    ds_read_b64_tr_b16 v[96:97], v10 offset:49152
    ds_read_b64_tr_b16 v[98:99], v10 offset:50176
    v_mfma_f32_32x32x16_bf16 v[48:63], v[116:119], a[184:187], v[48:63]
    ds_read_b64_tr_b16 v[100:101], v11 offset:49152
    ds_read_b64_tr_b16 v[102:103], v11 offset:50176
    s_waitcnt vmcnt(16)
    s_waitcnt lgkmcnt(4)
    v_mfma_f32_32x32x16_bf16 v[32:47], v[120:123], a[188:191], v[32:47]
    ds_read_b64_tr_b16 v[104:105], v10 offset:51200
    ds_read_b64_tr_b16 v[106:107], v10 offset:52224
    s_add_u32 s83, s69, s54
    s_add_u32 m0, s70, 32768
    s_nop 0
    buffer_load_dwordx4 v4, s[8:11], s83 offen lds
    v_mfma_f32_32x32x16_bf16 v[48:63], v[124:127], a[188:191], v[48:63]
    ds_read_b64_tr_b16 v[108:109], v11 offset:51200
    ds_read_b64_tr_b16 v[110:111], v11 offset:52224
    s_waitcnt vmcnt(16)
    s_waitcnt lgkmcnt(4)
    v_mfma_f32_32x32x16_bf16 v[32:47], v[96:99], a[192:195], v[32:47]
    ds_read_b64_tr_b16 v[112:113], v10 offset:53248
    ds_read_b64_tr_b16 v[114:115], v10 offset:54272
    v_mfma_f32_32x32x16_bf16 v[48:63], v[100:103], a[192:195], v[48:63]
    ds_read_b64_tr_b16 v[116:117], v11 offset:53248
    ds_read_b64_tr_b16 v[118:119], v11 offset:54272
    buffer_load_dwordx4 v5, s[8:11], s83 offen offset:1024 lds
    s_waitcnt vmcnt(16)
    s_waitcnt lgkmcnt(4)
    v_mfma_f32_32x32x16_bf16 v[32:47], v[104:107], a[196:199], v[32:47]
    ds_read_b64_tr_b16 v[120:121], v10 offset:55296
    ds_read_b64_tr_b16 v[122:123], v10 offset:56320
    v_mfma_f32_32x32x16_bf16 v[48:63], v[108:111], a[196:199], v[48:63]
    ds_read_b64_tr_b16 v[124:125], v11 offset:55296
    ds_read_b64_tr_b16 v[126:127], v11 offset:56320
    s_waitcnt vmcnt(15)
    s_waitcnt lgkmcnt(4)
    v_mfma_f32_32x32x16_bf16 v[32:47], v[112:115], a[200:203], v[32:47]
    ds_read_b64_tr_b16 v[96:97], v10 offset:57344
    ds_read_b64_tr_b16 v[98:99], v10 offset:58368
    buffer_load_dwordx4 v6, s[8:11], s83 offen offset:2048 lds
    v_mfma_f32_32x32x16_bf16 v[48:63], v[116:119], a[200:203], v[48:63]
    ds_read_b64_tr_b16 v[100:101], v11 offset:57344
    ds_read_b64_tr_b16 v[102:103], v11 offset:58368
    s_waitcnt vmcnt(15)
    s_waitcnt lgkmcnt(4)
    v_mfma_f32_32x32x16_bf16 v[32:47], v[120:123], a[204:207], v[32:47]
    ds_read_b64_tr_b16 v[104:105], v10 offset:59392
    ds_read_b64_tr_b16 v[106:107], v10 offset:60416
    v_mfma_f32_32x32x16_bf16 v[48:63], v[124:127], a[204:207], v[48:63]
    ds_read_b64_tr_b16 v[108:109], v11 offset:59392
    ds_read_b64_tr_b16 v[110:111], v11 offset:60416
    buffer_load_dwordx4 v7, s[8:11], s83 offen offset:3072 lds
    s_waitcnt vmcnt(15)
    s_waitcnt lgkmcnt(4)
    v_mfma_f32_32x32x16_bf16 v[32:47], v[96:99], a[208:211], v[32:47]
    ds_read_b64_tr_b16 v[112:113], v10 offset:61440
    ds_read_b64_tr_b16 v[114:115], v10 offset:62464
    v_mfma_f32_32x32x16_bf16 v[48:63], v[100:103], a[208:211], v[48:63]
    ds_read_b64_tr_b16 v[116:117], v11 offset:61440
    ds_read_b64_tr_b16 v[118:119], v11 offset:62464
    s_waitcnt vmcnt(14)
    s_waitcnt lgkmcnt(4)
    v_mfma_f32_32x32x16_bf16 v[32:47], v[104:107], a[212:215], v[32:47]
    ds_read_b64_tr_b16 v[120:121], v10 offset:63488
    ds_read_b64_tr_b16 v[122:123], v10 offset:64512
    v_mfma_f32_32x32x16_bf16 v[48:63], v[108:111], a[212:215], v[48:63]
    ds_read_b64_tr_b16 v[124:125], v11 offset:63488
    ds_read_b64_tr_b16 v[126:127], v11 offset:64512
    s_waitcnt vmcnt(8)
    s_barrier
    s_waitcnt vmcnt(13)
    s_waitcnt lgkmcnt(4)
    v_mfma_f32_32x32x16_bf16 v[32:47], v[112:115], a[216:219], v[32:47]
    ds_read_b64_tr_b16 v[96:97], v8 offset:0
    ds_read_b64_tr_b16 v[98:99], v8 offset:1024
    v_mfma_f32_32x32x16_bf16 v[48:63], v[116:119], a[216:219], v[48:63]
    ds_read_b64_tr_b16 v[100:101], v9 offset:0
    ds_read_b64_tr_b16 v[102:103], v9 offset:1024
    s_waitcnt vmcnt(12)
    s_waitcnt lgkmcnt(4)
    v_mfma_f32_32x32x16_bf16 v[32:47], v[120:123], a[220:223], v[32:47]
    ds_read_b64_tr_b16 v[104:105], v8 offset:2048
    ds_read_b64_tr_b16 v[106:107], v8 offset:3072
    v_mfma_f32_32x32x16_bf16 v[48:63], v[124:127], a[220:223], v[48:63]
    ds_read_b64_tr_b16 v[108:109], v9 offset:2048
    ds_read_b64_tr_b16 v[110:111], v9 offset:3072
    s_add_u32 s35, s35, 1
    s_mov_b32 s68, s69
    s_add_u32 s69, s68, 2097024
    s_cmp_ge_u32 s35, 5
    s_cselect_b32 s69, 0x7f000000, s69
    s_cmp_lt_u32 s35, 5
    s_cbranch_scc1 L_odd
    s_waitcnt lgkmcnt(4)
    v_mfma_f32_32x32x16_bf16 v[64:79], v[96:99], v[128:131], v[64:79]
    ds_read_b64_tr_b16 v[112:113], v8 offset:4096
    ds_read_b64_tr_b16 v[114:115], v8 offset:5120
    v_mfma_f32_32x32x16_bf16 v[80:95], v[100:103], v[128:131], v[80:95]
    ds_read_b64_tr_b16 v[116:117], v9 offset:4096
    ds_read_b64_tr_b16 v[118:119], v9 offset:5120
    s_add_u32 s83, s68, s55
    s_add_u32 m0, s70, 49152
    s_nop 0
    buffer_load_dwordx4 v4, s[8:11], s83 offen lds
    s_waitcnt lgkmcnt(4)
    v_mfma_f32_32x32x16_bf16 v[64:79], v[104:107], v[132:135], v[64:79]
    ds_read_b64_tr_b16 v[120:121], v8 offset:6144
    ds_read_b64_tr_b16 v[122:123], v8 offset:7168
    v_mfma_f32_32x32x16_bf16 v[80:95], v[108:111], v[132:135], v[80:95]
    ds_read_b64_tr_b16 v[124:125], v9 offset:6144
    ds_read_b64_tr_b16 v[126:127], v9 offset:7168
    s_waitcnt lgkmcnt(4)
    v_mfma_f32_32x32x16_bf16 v[64:79], v[112:115], v[136:139], v[64:79]
    ds_read_b64_tr_b16 v[96:97], v8 offset:8192
    ds_read_b64_tr_b16 v[98:99], v8 offset:9216
    buffer_load_dwordx4 v5, s[8:11], s83 offen offset:1024 lds
    v_mfma_f32_32x32x16_bf16 v[80:95], v[116:119], v[136:139], v[80:95]
    ds_read_b64_tr_b16 v[100:101], v9 offset:8192
    ds_read_b64_tr_b16 v[102:103], v9 offset:9216
    s_waitcnt lgkmcnt(4)
    v_mfma_f32_32x32x16_bf16 v[64:79], v[120:123], v[140:143], v[64:79]
    ds_read_b64_tr_b16 v[104:105], v8 offset:10240
    ds_read_b64_tr_b16 v[106:107], v8 offset:11264
    v_mfma_f32_32x32x16_bf16 v[80:95], v[124:127], v[140:143], v[80:95]
    ds_read_b64_tr_b16 v[108:109], v9 offset:10240
    ds_read_b64_tr_b16 v[110:111], v9 offset:11264
    buffer_load_dwordx4 v6, s[8:11], s83 offen offset:2048 lds
    s_waitcnt lgkmcnt(4)
    v_mfma_f32_32x32x16_bf16 v[64:79], v[96:99], a[0:3], v[64:79]
    ds_read_b64_tr_b16 v[112:113], v8 offset:12288
    ds_read_b64_tr_b16 v[114:115], v8 offset:13312
    v_lshlrev_b32 v192, 16, v160
    v_and_b32 v193, s79, v160
    v_lshlrev_b32 v194, 16, v128
    v_and_b32 v195, s79, v128
    v_mfma_f32_32x32x16_bf16 v[80:95], v[100:103], a[0:3], v[80:95]
    ds_read_b64_tr_b16 v[116:117], v9 offset:12288
    ds_read_b64_tr_b16 v[118:119], v9 offset:13312
    v_fma_f32 v194, v192, v32, v194
    v_fma_f32 v195, v193, v33, v195
    v_cvt_pk_bf16_f32 v128, v194, v195
    v_lshlrev_b32 v196, 16, v161
    s_waitcnt lgkmcnt(4)
    v_mfma_f32_32x32x16_bf16 v[64:79], v[104:107], a[4:7], v[64:79]
    ds_read_b64_tr_b16 v[120:121], v8 offset:14336
    ds_read_b64_tr_b16 v[122:123], v8 offset:15360
    buffer_load_dwordx4 v7, s[8:11], s83 offen offset:3072 lds
    v_and_b32 v197, s79, v161
    v_lshlrev_b32 v198, 16, v129
    v_and_b32 v199, s79, v129
    v_fma_f32 v198, v196, v34, v198
    v_mfma_f32_32x32x16_bf16 v[80:95], v[108:111], a[4:7], v[80:95]
    ds_read_b64_tr_b16 v[124:125], v9 offset:14336
    ds_read_b64_tr_b16 v[126:127], v9 offset:15360
    v_fma_f32 v199, v197, v35, v199
    v_cvt_pk_bf16_f32 v129, v198, v199
    v_lshlrev_b32 v200, 16, v162
    v_and_b32 v201, s79, v162
    s_waitcnt vmcnt(8)
    s_barrier
    s_waitcnt lgkmcnt(4)
    v_mfma_f32_32x32x16_bf16 v[64:79], v[112:115], a[8:11], v[64:79]
    ds_read_b64_tr_b16 v[96:97], v8 offset:16384
    ds_read_b64_tr_b16 v[98:99], v8 offset:17408
    v_lshlrev_b32 v202, 16, v130
    v_and_b32 v203, s79, v130
    v_fma_f32 v202, v200, v36, v202
    v_fma_f32 v203, v201, v37, v203
    v_mfma_f32_32x32x16_bf16 v[80:95], v[116:119], a[8:11], v[80:95]
    ds_read_b64_tr_b16 v[100:101], v9 offset:16384
    ds_read_b64_tr_b16 v[102:103], v9 offset:17408
    s_add_u32 s83, s68, s56
    s_add_u32 m0, s70, 65536
    s_nop 0
    buffer_load_dwordx4 v4, s[8:11], s83 offen lds
    v_cvt_pk_bf16_f32 v130, v202, v203
    v_lshlrev_b32 v204, 16, v163
    v_and_b32 v205, s79, v163
    v_lshlrev_b32 v206, 16, v131
    s_waitcnt lgkmcnt(4)
    v_mfma_f32_32x32x16_bf16 v[64:79], v[120:123], a[12:15], v[64:79]
    ds_read_b64_tr_b16 v[104:105], v8 offset:18432
    ds_read_b64_tr_b16 v[106:107], v8 offset:19456
    v_and_b32 v207, s79, v131
    v_fma_f32 v206, v204, v38, v206
    v_fma_f32 v207, v205, v39, v207
    v_cvt_pk_bf16_f32 v131, v206, v207
    v_mfma_f32_32x32x16_bf16 v[80:95], v[124:127], a[12:15], v[80:95]
    ds_read_b64_tr_b16 v[108:109], v9 offset:18432
    ds_read_b64_tr_b16 v[110:111], v9 offset:19456
    s_nop 1
    v_permlane32_swap_b32 v128, v130
    v_permlane32_swap_b32 v129, v131
    v_xor_b32 v20, 0, v234
    s_waitcnt lgkmcnt(4)
    v_mfma_f32_32x32x16_bf16 v[64:79], v[96:99], a[16:19], v[64:79]
    ds_read_b64_tr_b16 v[112:113], v8 offset:20480
    ds_read_b64_tr_b16 v[114:115], v8 offset:21504
    buffer_load_dwordx4 v5, s[8:11], s83 offen offset:1024 lds
    ds_write_b128 v20, v[128:131]
    v_lshlrev_b32 v192, 16, v164
    v_and_b32 v193, s79, v164
    v_lshlrev_b32 v194, 16, v132
    v_mfma_f32_32x32x16_bf16 v[80:95], v[100:103], a[16:19], v[80:95]
    ds_read_b64_tr_b16 v[116:117], v9 offset:20480
    ds_read_b64_tr_b16 v[118:119], v9 offset:21504
    v_and_b32 v195, s79, v132
    v_fma_f32 v194, v192, v40, v194
    v_fma_f32 v195, v193, v41, v195
    v_cvt_pk_bf16_f32 v132, v194, v195
    s_waitcnt lgkmcnt(4)
    v_mfma_f32_32x32x16_bf16 v[64:79], v[104:107], a[20:23], v[64:79]
    ds_read_b64_tr_b16 v[120:121], v8 offset:22528
    ds_read_b64_tr_b16 v[122:123], v8 offset:23552
    v_lshlrev_b32 v196, 16, v165
    v_and_b32 v197, s79, v165
    v_lshlrev_b32 v198, 16, v133
    v_and_b32 v199, s79, v133
    v_mfma_f32_32x32x16_bf16 v[80:95], v[108:111], a[20:23], v[80:95]
    ds_read_b64_tr_b16 v[124:125], v9 offset:22528
    ds_read_b64_tr_b16 v[126:127], v9 offset:23552
    buffer_load_dwordx4 v6, s[8:11], s83 offen offset:2048 lds
    v_fma_f32 v198, v196, v42, v198
    v_fma_f32 v199, v197, v43, v199
    v_cvt_pk_bf16_f32 v133, v198, v199
    v_lshlrev_b32 v200, 16, v166
    s_waitcnt lgkmcnt(4)
    v_mfma_f32_32x32x16_bf16 v[64:79], v[112:115], a[24:27], v[64:79]
    ds_read_b64_tr_b16 v[96:97], v8 offset:24576
    ds_read_b64_tr_b16 v[98:99], v8 offset:25600
    v_and_b32 v201, s79, v166
    v_lshlrev_b32 v202, 16, v134
    v_and_b32 v203, s79, v134
    v_fma_f32 v202, v200, v44, v202
    v_mfma_f32_32x32x16_bf16 v[80:95], v[116:119], a[24:27], v[80:95]
    ds_read_b64_tr_b16 v[100:101], v9 offset:24576
    ds_read_b64_tr_b16 v[102:103], v9 offset:25600
    v_fma_f32 v203, v201, v45, v203
    v_cvt_pk_bf16_f32 v134, v202, v203
    v_lshlrev_b32 v204, 16, v167
    v_and_b32 v205, s79, v167
    s_waitcnt lgkmcnt(4)
    v_mfma_f32_32x32x16_bf16 v[64:79], v[120:123], a[28:31], v[64:79]
    ds_read_b64_tr_b16 v[104:105], v8 offset:26624
    ds_read_b64_tr_b16 v[106:107], v8 offset:27648
    buffer_load_dwordx4 v7, s[8:11], s83 offen offset:3072 lds
    v_lshlrev_b32 v206, 16, v135
    v_and_b32 v207, s79, v135
    v_fma_f32 v206, v204, v46, v206
    v_fma_f32 v207, v205, v47, v207
    v_mfma_f32_32x32x16_bf16 v[80:95], v[124:127], a[28:31], v[80:95]
    ds_read_b64_tr_b16 v[108:109], v9 offset:26624
    ds_read_b64_tr_b16 v[110:111], v9 offset:27648
    v_cvt_pk_bf16_f32 v135, v206, v207
    s_nop 1
    v_permlane32_swap_b32 v132, v134
    v_permlane32_swap_b32 v133, v135
    s_waitcnt lgkmcnt(4)
    v_mfma_f32_32x32x16_bf16 v[64:79], v[96:99], a[32:35], v[64:79]
    ds_read_b64_tr_b16 v[112:113], v8 offset:28672
    ds_read_b64_tr_b16 v[114:115], v8 offset:29696
    v_xor_b32 v20, 32, v234
    ds_write_b128 v20, v[132:135]
    v_lshlrev_b32 v192, 16, v168
    v_and_b32 v193, s79, v168
    v_mfma_f32_32x32x16_bf16 v[80:95], v[100:103], a[32:35], v[80:95]
    ds_read_b64_tr_b16 v[116:117], v9 offset:28672
    ds_read_b64_tr_b16 v[118:119], v9 offset:29696
    s_add_u32 s83, s68, s57
    s_add_u32 m0, s70, 81920
    s_nop 0
    buffer_load_dwordx4 v4, s[8:11], s83 offen lds
    v_lshlrev_b32 v194, 16, v136
    v_and_b32 v195, s79, v136
    v_fma_f32 v194, v192, v48, v194
    v_fma_f32 v195, v193, v49, v195
    s_waitcnt lgkmcnt(4)
    v_mfma_f32_32x32x16_bf16 v[64:79], v[104:107], a[36:39], v[64:79]
    ds_read_b64_tr_b16 v[120:121], v8 offset:30720
    ds_read_b64_tr_b16 v[122:123], v8 offset:31744
    v_cvt_pk_bf16_f32 v136, v194, v195
    v_lshlrev_b32 v196, 16, v169
    v_and_b32 v197, s79, v169
    v_lshlrev_b32 v198, 16, v137
    v_mfma_f32_32x32x16_bf16 v[80:95], v[108:111], a[36:39], v[80:95]
    ds_read_b64_tr_b16 v[124:125], v9 offset:30720
    ds_read_b64_tr_b16 v[126:127], v9 offset:31744
    v_and_b32 v199, s79, v137
    v_fma_f32 v198, v196, v50, v198
    v_fma_f32 v199, v197, v51, v199
    v_cvt_pk_bf16_f32 v137, v198, v199
    s_waitcnt vmcnt(9)
    s_barrier
    s_waitcnt lgkmcnt(4)
    v_mfma_f32_32x32x16_bf16 v[64:79], v[112:115], a[40:43], v[64:79]
    ds_read_b64_tr_b16 v[96:97], v8 offset:32768
    ds_read_b64_tr_b16 v[98:99], v8 offset:33792
    buffer_load_dwordx4 v5, s[8:11], s83 offen offset:1024 lds
    v_lshlrev_b32 v200, 16, v170
    v_and_b32 v201, s79, v170
    v_lshlrev_b32 v202, 16, v138
    v_and_b32 v203, s79, v138
    v_mfma_f32_32x32x16_bf16 v[80:95], v[116:119], a[40:43], v[80:95]
    ds_read_b64_tr_b16 v[100:101], v9 offset:32768
    ds_read_b64_tr_b16 v[102:103], v9 offset:33792
    v_fma_f32 v202, v200, v52, v202
    v_fma_f32 v203, v201, v53, v203
    v_cvt_pk_bf16_f32 v138, v202, v203
    v_lshlrev_b32 v204, 16, v171
    s_waitcnt lgkmcnt(4)
    v_mfma_f32_32x32x16_bf16 v[64:79], v[120:123], a[44:47], v[64:79]
    ds_read_b64_tr_b16 v[104:105], v8 offset:34816
    ds_read_b64_tr_b16 v[106:107], v8 offset:35840
    v_and_b32 v205, s79, v171
    v_lshlrev_b32 v206, 16, v139
    v_and_b32 v207, s79, v139
    v_fma_f32 v206, v204, v54, v206
    v_mfma_f32_32x32x16_bf16 v[80:95], v[124:127], a[44:47], v[80:95]
    ds_read_b64_tr_b16 v[108:109], v9 offset:34816
    ds_read_b64_tr_b16 v[110:111], v9 offset:35840
    buffer_load_dwordx4 v6, s[8:11], s83 offen offset:2048 lds
    v_fma_f32 v207, v205, v55, v207
    v_cvt_pk_bf16_f32 v139, v206, v207
    s_nop 1
    v_permlane32_swap_b32 v136, v138
    s_waitcnt lgkmcnt(4)
    v_mfma_f32_32x32x16_bf16 v[64:79], v[96:99], a[48:51], v[64:79]
    ds_read_b64_tr_b16 v[112:113], v8 offset:36864
    ds_read_b64_tr_b16 v[114:115], v8 offset:37888
    v_permlane32_swap_b32 v137, v139
    v_xor_b32 v20, 64, v234
    ds_write_b128 v20, v[136:139]
    v_lshlrev_b32 v192, 16, v172
    v_mfma_f32_32x32x16_bf16 v[80:95], v[100:103], a[48:51], v[80:95]
    ds_read_b64_tr_b16 v[116:117], v9 offset:36864
    ds_read_b64_tr_b16 v[118:119], v9 offset:37888
    v_and_b32 v193, s79, v172
    v_lshlrev_b32 v194, 16, v140
    v_and_b32 v195, s79, v140
    v_fma_f32 v194, v192, v56, v194
    s_waitcnt lgkmcnt(4)
    v_mfma_f32_32x32x16_bf16 v[64:79], v[104:107], a[52:55], v[64:79]
    ds_read_b64_tr_b16 v[120:121], v8 offset:38912
    ds_read_b64_tr_b16 v[122:123], v8 offset:39936
    buffer_load_dwordx4 v7, s[8:11], s83 offen offset:3072 lds
    v_fma_f32 v195, v193, v57, v195
    v_cvt_pk_bf16_f32 v140, v194, v195
    v_lshlrev_b32 v196, 16, v173
    v_and_b32 v197, s79, v173
    v_mfma_f32_32x32x16_bf16 v[80:95], v[108:111], a[52:55], v[80:95]
    ds_read_b64_tr_b16 v[124:125], v9 offset:38912
    ds_read_b64_tr_b16 v[126:127], v9 offset:39936
    v_lshlrev_b32 v198, 16, v141
    v_and_b32 v199, s79, v141
    v_fma_f32 v198, v196, v58, v198
    v_fma_f32 v199, v197, v59, v199
    s_waitcnt lgkmcnt(4)
    v_mfma_f32_32x32x16_bf16 v[64:79], v[112:115], a[56:59], v[64:79]
    ds_read_b64_tr_b16 v[96:97], v8 offset:40960
    ds_read_b64_tr_b16 v[98:99], v8 offset:41984
    v_cvt_pk_bf16_f32 v141, v198, v199
    v_lshlrev_b32 v200, 16, v174
    v_and_b32 v201, s79, v174
    v_lshlrev_b32 v202, 16, v142
    v_mfma_f32_32x32x16_bf16 v[80:95], v[116:119], a[56:59], v[80:95]
    ds_read_b64_tr_b16 v[100:101], v9 offset:40960
    ds_read_b64_tr_b16 v[102:103], v9 offset:41984
    s_add_u32 s83, s68, s58
    s_add_u32 m0, s70, 98304
    s_nop 0
    buffer_load_dwordx4 v4, s[8:11], s83 offen lds
    v_and_b32 v203, s79, v142
    v_fma_f32 v202, v200, v60, v202
    v_fma_f32 v203, v201, v61, v203
    v_cvt_pk_bf16_f32 v142, v202, v203
    s_waitcnt lgkmcnt(4)
    v_mfma_f32_32x32x16_bf16 v[64:79], v[120:123], a[60:63], v[64:79]
    ds_read_b64_tr_b16 v[104:105], v8 offset:43008
    ds_read_b64_tr_b16 v[106:107], v8 offset:44032
    v_lshlrev_b32 v204, 16, v175
    v_and_b32 v205, s79, v175
    v_lshlrev_b32 v206, 16, v143
    v_and_b32 v207, s79, v143
    v_mfma_f32_32x32x16_bf16 v[80:95], v[124:127], a[60:63], v[80:95]
    ds_read_b64_tr_b16 v[108:109], v9 offset:43008
    ds_read_b64_tr_b16 v[110:111], v9 offset:44032
    v_fma_f32 v206, v204, v62, v206
    v_fma_f32 v207, v205, v63, v207
    v_cvt_pk_bf16_f32 v143, v206, v207
    s_nop 1
    s_waitcnt lgkmcnt(4)
    v_mfma_f32_32x32x16_bf16 v[64:79], v[96:99], a[64:67], v[64:79]
    ds_read_b64_tr_b16 v[112:113], v8 offset:45056
    ds_read_b64_tr_b16 v[114:115], v8 offset:46080
    buffer_load_dwordx4 v5, s[8:11], s83 offen offset:1024 lds
    v_permlane32_swap_b32 v140, v142
    v_permlane32_swap_b32 v141, v143
    v_xor_b32 v20, 96, v234
    ds_write_b128 v20, v[140:143]
    v_mfma_f32_32x32x16_bf16 v[80:95], v[100:103], a[64:67], v[80:95]
    ds_read_b64_tr_b16 v[116:117], v9 offset:45056
    ds_read_b64_tr_b16 v[118:119], v9 offset:46080
    ds_read_b128 v[192:195], v240 offset:0
    ds_read_b128 v[196:199], v241 offset:1024
    ds_read_b128 v[200:203], v240 offset:2048
    ds_read_b128 v[204:207], v241 offset:3072
    s_waitcnt lgkmcnt(4)
    v_mfma_f32_32x32x16_bf16 v[64:79], v[104:107], a[68:71], v[64:79]
    ds_read_b64_tr_b16 v[120:121], v8 offset:47104
    ds_read_b64_tr_b16 v[122:123], v8 offset:48128
    s_waitcnt lgkmcnt(0)
    buffer_store_dwordx4 v[192:195], v13, s[20:23], s88 offen offset:0 sc0 sc1
    v_mfma_f32_32x32x16_bf16 v[80:95], v[108:111], a[68:71], v[80:95]
    ds_read_b64_tr_b16 v[124:125], v9 offset:47104
    ds_read_b64_tr_b16 v[126:127], v9 offset:48128
    buffer_load_dwordx4 v6, s[8:11], s83 offen offset:2048 lds
    s_waitcnt vmcnt(12)
    s_barrier
    s_waitcnt lgkmcnt(4)
    v_mfma_f32_32x32x16_bf16 v[64:79], v[112:115], a[72:75], v[64:79]
    ds_read_b64_tr_b16 v[96:97], v8 offset:49152
    ds_read_b64_tr_b16 v[98:99], v8 offset:50176
    buffer_store_dwordx4 v[196:199], v13, s[20:23], s89 offen offset:0 sc0 sc1
    v_mfma_f32_32x32x16_bf16 v[80:95], v[116:119], a[72:75], v[80:95]
    ds_read_b64_tr_b16 v[100:101], v9 offset:49152
    ds_read_b64_tr_b16 v[102:103], v9 offset:50176
    buffer_store_dwordx4 v[200:203], v13, s[20:23], s90 offen offset:0 sc0 sc1
    s_waitcnt lgkmcnt(4)
    v_mfma_f32_32x32x16_bf16 v[64:79], v[120:123], a[76:79], v[64:79]
    ds_read_b64_tr_b16 v[104:105], v8 offset:51200
    ds_read_b64_tr_b16 v[106:107], v8 offset:52224
    buffer_load_dwordx4 v7, s[8:11], s83 offen offset:3072 lds
    v_mfma_f32_32x32x16_bf16 v[80:95], v[124:127], a[76:79], v[80:95]
    ds_read_b64_tr_b16 v[108:109], v9 offset:51200
    ds_read_b64_tr_b16 v[110:111], v9 offset:52224
    buffer_store_dwordx4 v[204:207], v13, s[20:23], s91 offen offset:0 sc0 sc1
    s_waitcnt lgkmcnt(4)
    v_mfma_f32_32x32x16_bf16 v[64:79], v[96:99], a[80:83], v[64:79]
    ds_read_b64_tr_b16 v[112:113], v8 offset:53248
    ds_read_b64_tr_b16 v[114:115], v8 offset:54272
    v_mfma_f32_32x32x16_bf16 v[80:95], v[100:103], a[80:83], v[80:95]
    ds_read_b64_tr_b16 v[116:117], v9 offset:53248
    ds_read_b64_tr_b16 v[118:119], v9 offset:54272
    s_add_u32 s83, s68, s59
    s_add_u32 m0, s70, 114688
    s_nop 0
    buffer_load_dwordx4 v4, s[8:11], s83 offen lds
    s_waitcnt lgkmcnt(4)
    v_mfma_f32_32x32x16_bf16 v[64:79], v[104:107], a[84:87], v[64:79]
    ds_read_b64_tr_b16 v[120:121], v8 offset:55296
    ds_read_b64_tr_b16 v[122:123], v8 offset:56320
    v_mfma_f32_32x32x16_bf16 v[80:95], v[108:111], a[84:87], v[80:95]
    ds_read_b64_tr_b16 v[124:125], v9 offset:55296
    ds_read_b64_tr_b16 v[126:127], v9 offset:56320
    s_waitcnt lgkmcnt(4)
    v_mfma_f32_32x32x16_bf16 v[64:79], v[112:115], a[88:91], v[64:79]
    ds_read_b64_tr_b16 v[96:97], v8 offset:57344
    ds_read_b64_tr_b16 v[98:99], v8 offset:58368
    buffer_load_dwordx4 v5, s[8:11], s83 offen offset:1024 lds
    v_mfma_f32_32x32x16_bf16 v[80:95], v[116:119], a[88:91], v[80:95]
    ds_read_b64_tr_b16 v[100:101], v9 offset:57344
    ds_read_b64_tr_b16 v[102:103], v9 offset:58368
    s_waitcnt lgkmcnt(4)
    v_mfma_f32_32x32x16_bf16 v[64:79], v[120:123], a[92:95], v[64:79]
    ds_read_b64_tr_b16 v[104:105], v8 offset:59392
    ds_read_b64_tr_b16 v[106:107], v8 offset:60416
    v_mfma_f32_32x32x16_bf16 v[80:95], v[124:127], a[92:95], v[80:95]
    ds_read_b64_tr_b16 v[108:109], v9 offset:59392
    ds_read_b64_tr_b16 v[110:111], v9 offset:60416
    buffer_load_dwordx4 v6, s[8:11], s83 offen offset:2048 lds
    s_waitcnt lgkmcnt(4)
    v_mfma_f32_32x32x16_bf16 v[64:79], v[96:99], a[96:99], v[64:79]
    ds_read_b64_tr_b16 v[112:113], v8 offset:61440
    ds_read_b64_tr_b16 v[114:115], v8 offset:62464
    v_mfma_f32_32x32x16_bf16 v[80:95], v[100:103], a[96:99], v[80:95]
    ds_read_b64_tr_b16 v[116:117], v9 offset:61440
    ds_read_b64_tr_b16 v[118:119], v9 offset:62464
    s_waitcnt lgkmcnt(4)
    v_mfma_f32_32x32x16_bf16 v[64:79], v[104:107], a[100:103], v[64:79]
    ds_read_b64_tr_b16 v[120:121], v8 offset:63488
    ds_read_b64_tr_b16 v[122:123], v8 offset:64512
    buffer_load_dwordx4 v7, s[8:11], s83 offen offset:3072 lds
    v_mfma_f32_32x32x16_bf16 v[80:95], v[108:111], a[100:103], v[80:95]
    ds_read_b64_tr_b16 v[124:125], v9 offset:63488
    ds_read_b64_tr_b16 v[126:127], v9 offset:64512
    s_waitcnt vmcnt(16)
    s_barrier
    s_waitcnt lgkmcnt(4)
    v_mfma_f32_32x32x16_bf16 v[64:79], v[112:115], a[104:107], v[64:79]
    ds_read_b64_tr_b16 v[96:97], v10 offset:0
    ds_read_b64_tr_b16 v[98:99], v10 offset:1024
    v_mfma_f32_32x32x16_bf16 v[80:95], v[116:119], a[104:107], v[80:95]
    ds_read_b64_tr_b16 v[100:101], v11 offset:0
    ds_read_b64_tr_b16 v[102:103], v11 offset:1024
    s_waitcnt lgkmcnt(4)
    v_mfma_f32_32x32x16_bf16 v[64:79], v[120:123], a[108:111], v[64:79]
    ds_read_b64_tr_b16 v[104:105], v10 offset:2048
    ds_read_b64_tr_b16 v[106:107], v10 offset:3072
    v_mfma_f32_32x32x16_bf16 v[80:95], v[124:127], a[108:111], v[80:95]
    ds_read_b64_tr_b16 v[108:109], v11 offset:2048
    ds_read_b64_tr_b16 v[110:111], v11 offset:3072
    s_waitcnt lgkmcnt(4)
    v_mfma_f32_32x32x16_bf16 v[64:79], v[96:99], v[144:147], v[64:79]
    ds_read_b64_tr_b16 v[112:113], v10 offset:4096
    ds_read_b64_tr_b16 v[114:115], v10 offset:5120
    v_mfma_f32_32x32x16_bf16 v[80:95], v[100:103], v[144:147], v[80:95]
    ds_read_b64_tr_b16 v[116:117], v11 offset:4096
    ds_read_b64_tr_b16 v[118:119], v11 offset:5120
    s_waitcnt lgkmcnt(4)
    v_mfma_f32_32x32x16_bf16 v[64:79], v[104:107], v[148:151], v[64:79]
    ds_read_b64_tr_b16 v[120:121], v10 offset:6144
    ds_read_b64_tr_b16 v[122:123], v10 offset:7168
    v_mfma_f32_32x32x16_bf16 v[80:95], v[108:111], v[148:151], v[80:95]
    ds_read_b64_tr_b16 v[124:125], v11 offset:6144
    ds_read_b64_tr_b16 v[126:127], v11 offset:7168
    s_waitcnt lgkmcnt(4)
    v_mfma_f32_32x32x16_bf16 v[64:79], v[112:115], v[152:155], v[64:79]
    ds_read_b64_tr_b16 v[96:97], v10 offset:8192
    ds_read_b64_tr_b16 v[98:99], v10 offset:9216
    v_mfma_f32_32x32x16_bf16 v[80:95], v[116:119], v[152:155], v[80:95]
    ds_read_b64_tr_b16 v[100:101], v11 offset:8192
    ds_read_b64_tr_b16 v[102:103], v11 offset:9216
    s_waitcnt lgkmcnt(4)
    v_mfma_f32_32x32x16_bf16 v[64:79], v[120:123], v[156:159], v[64:79]
    ds_read_b64_tr_b16 v[104:105], v10 offset:10240
    ds_read_b64_tr_b16 v[106:107], v10 offset:11264
    v_mfma_f32_32x32x16_bf16 v[80:95], v[124:127], v[156:159], v[80:95]
    ds_read_b64_tr_b16 v[108:109], v11 offset:10240
    ds_read_b64_tr_b16 v[110:111], v11 offset:11264
    s_waitcnt lgkmcnt(4)
    v_mfma_f32_32x32x16_bf16 v[64:79], v[96:99], a[112:115], v[64:79]
    ds_read_b64_tr_b16 v[112:113], v10 offset:12288
    ds_read_b64_tr_b16 v[114:115], v10 offset:13312
    v_mfma_f32_32x32x16_bf16 v[80:95], v[100:103], a[112:115], v[80:95]
    ds_read_b64_tr_b16 v[116:117], v11 offset:12288
    ds_read_b64_tr_b16 v[118:119], v11 offset:13312
    s_waitcnt lgkmcnt(4)
    v_mfma_f32_32x32x16_bf16 v[64:79], v[104:107], a[116:119], v[64:79]
    ds_read_b64_tr_b16 v[120:121], v10 offset:14336
    ds_read_b64_tr_b16 v[122:123], v10 offset:15360
    v_mfma_f32_32x32x16_bf16 v[80:95], v[108:111], a[116:119], v[80:95]
    ds_read_b64_tr_b16 v[124:125], v11 offset:14336
    ds_read_b64_tr_b16 v[126:127], v11 offset:15360
    s_waitcnt vmcnt(12)
    s_barrier
    s_waitcnt lgkmcnt(4)
    v_mfma_f32_32x32x16_bf16 v[64:79], v[112:115], a[120:123], v[64:79]
    ds_read_b64_tr_b16 v[96:97], v10 offset:16384
    ds_read_b64_tr_b16 v[98:99], v10 offset:17408
    v_mfma_f32_32x32x16_bf16 v[80:95], v[116:119], a[120:123], v[80:95]
    ds_read_b64_tr_b16 v[100:101], v11 offset:16384
    ds_read_b64_tr_b16 v[102:103], v11 offset:17408
    s_waitcnt lgkmcnt(4)
    v_mfma_f32_32x32x16_bf16 v[64:79], v[120:123], a[124:127], v[64:79]
    ds_read_b64_tr_b16 v[104:105], v10 offset:18432
    ds_read_b64_tr_b16 v[106:107], v10 offset:19456
    v_mfma_f32_32x32x16_bf16 v[80:95], v[124:127], a[124:127], v[80:95]
    ds_read_b64_tr_b16 v[108:109], v11 offset:18432
    ds_read_b64_tr_b16 v[110:111], v11 offset:19456
    s_waitcnt lgkmcnt(4)
    v_mfma_f32_32x32x16_bf16 v[64:79], v[96:99], a[128:131], v[64:79]
    ds_read_b64_tr_b16 v[112:113], v10 offset:20480
    ds_read_b64_tr_b16 v[114:115], v10 offset:21504
    v_mfma_f32_32x32x16_bf16 v[80:95], v[100:103], a[128:131], v[80:95]
    ds_read_b64_tr_b16 v[116:117], v11 offset:20480
    ds_read_b64_tr_b16 v[118:119], v11 offset:21504
    s_waitcnt lgkmcnt(4)
    v_mfma_f32_32x32x16_bf16 v[64:79], v[104:107], a[132:135], v[64:79]
    ds_read_b64_tr_b16 v[120:121], v10 offset:22528
    ds_read_b64_tr_b16 v[122:123], v10 offset:23552
    v_mfma_f32_32x32x16_bf16 v[80:95], v[108:111], a[132:135], v[80:95]
    ds_read_b64_tr_b16 v[124:125], v11 offset:22528
    ds_read_b64_tr_b16 v[126:127], v11 offset:23552
    s_waitcnt lgkmcnt(4)
    v_mfma_f32_32x32x16_bf16 v[64:79], v[112:115], a[136:139], v[64:79]
    ds_read_b64_tr_b16 v[96:97], v10 offset:24576
    ds_read_b64_tr_b16 v[98:99], v10 offset:25600
    v_mfma_f32_32x32x16_bf16 v[80:95], v[116:119], a[136:139], v[80:95]
    ds_read_b64_tr_b16 v[100:101], v11 offset:24576
    ds_read_b64_tr_b16 v[102:103], v11 offset:25600
    s_waitcnt lgkmcnt(4)
    v_mfma_f32_32x32x16_bf16 v[64:79], v[120:123], a[140:143], v[64:79]
    ds_read_b64_tr_b16 v[104:105], v10 offset:26624
    ds_read_b64_tr_b16 v[106:107], v10 offset:27648
    v_mfma_f32_32x32x16_bf16 v[80:95], v[124:127], a[140:143], v[80:95]
    ds_read_b64_tr_b16 v[108:109], v11 offset:26624
    ds_read_b64_tr_b16 v[110:111], v11 offset:27648
    s_waitcnt lgkmcnt(4)
    v_mfma_f32_32x32x16_bf16 v[64:79], v[96:99], a[144:147], v[64:79]
    ds_read_b64_tr_b16 v[112:113], v10 offset:28672
    ds_read_b64_tr_b16 v[114:115], v10 offset:29696
    v_mfma_f32_32x32x16_bf16 v[80:95], v[100:103], a[144:147], v[80:95]
    ds_read_b64_tr_b16 v[116:117], v11 offset:28672
    ds_read_b64_tr_b16 v[118:119], v11 offset:29696
    s_waitcnt lgkmcnt(4)
    v_mfma_f32_32x32x16_bf16 v[64:79], v[104:107], a[148:151], v[64:79]
    ds_read_b64_tr_b16 v[120:121], v10 offset:30720
    ds_read_b64_tr_b16 v[122:123], v10 offset:31744
    v_mfma_f32_32x32x16_bf16 v[80:95], v[108:111], a[148:151], v[80:95]
    ds_read_b64_tr_b16 v[124:125], v11 offset:30720
    ds_read_b64_tr_b16 v[126:127], v11 offset:31744
    s_waitcnt vmcnt(5)
    s_barrier
    s_waitcnt lgkmcnt(4)
    v_mfma_f32_32x32x16_bf16 v[64:79], v[112:115], a[152:155], v[64:79]
    ds_read_b64_tr_b16 v[96:97], v10 offset:32768
    ds_read_b64_tr_b16 v[98:99], v10 offset:33792
    v_mfma_f32_32x32x16_bf16 v[80:95], v[116:119], a[152:155], v[80:95]
    ds_read_b64_tr_b16 v[100:101], v11 offset:32768
    ds_read_b64_tr_b16 v[102:103], v11 offset:33792
    s_waitcnt lgkmcnt(4)
    v_mfma_f32_32x32x16_bf16 v[64:79], v[120:123], a[156:159], v[64:79]
    ds_read_b64_tr_b16 v[104:105], v10 offset:34816
    ds_read_b64_tr_b16 v[106:107], v10 offset:35840
    v_mfma_f32_32x32x16_bf16 v[80:95], v[124:127], a[156:159], v[80:95]
    ds_read_b64_tr_b16 v[108:109], v11 offset:34816
    ds_read_b64_tr_b16 v[110:111], v11 offset:35840
    s_waitcnt lgkmcnt(4)
    v_mfma_f32_32x32x16_bf16 v[64:79], v[96:99], a[160:163], v[64:79]
    ds_read_b64_tr_b16 v[112:113], v10 offset:36864
    ds_read_b64_tr_b16 v[114:115], v10 offset:37888
    v_mfma_f32_32x32x16_bf16 v[80:95], v[100:103], a[160:163], v[80:95]
    ds_read_b64_tr_b16 v[116:117], v11 offset:36864
    ds_read_b64_tr_b16 v[118:119], v11 offset:37888
    s_waitcnt lgkmcnt(4)
    v_mfma_f32_32x32x16_bf16 v[64:79], v[104:107], a[164:167], v[64:79]
    ds_read_b64_tr_b16 v[120:121], v10 offset:38912
    ds_read_b64_tr_b16 v[122:123], v10 offset:39936
    v_mfma_f32_32x32x16_bf16 v[80:95], v[108:111], a[164:167], v[80:95]
    ds_read_b64_tr_b16 v[124:125], v11 offset:38912
    ds_read_b64_tr_b16 v[126:127], v11 offset:39936
    s_waitcnt lgkmcnt(4)
    v_mfma_f32_32x32x16_bf16 v[64:79], v[112:115], a[168:171], v[64:79]
    ds_read_b64_tr_b16 v[96:97], v10 offset:40960
    ds_read_b64_tr_b16 v[98:99], v10 offset:41984
    v_mfma_f32_32x32x16_bf16 v[80:95], v[116:119], a[168:171], v[80:95]
    ds_read_b64_tr_b16 v[100:101], v11 offset:40960
    ds_read_b64_tr_b16 v[102:103], v11 offset:41984
    s_waitcnt lgkmcnt(4)
    v_mfma_f32_32x32x16_bf16 v[64:79], v[120:123], a[172:175], v[64:79]
    ds_read_b64_tr_b16 v[104:105], v10 offset:43008
    ds_read_b64_tr_b16 v[106:107], v10 offset:44032
    v_mfma_f32_32x32x16_bf16 v[80:95], v[124:127], a[172:175], v[80:95]
    ds_read_b64_tr_b16 v[108:109], v11 offset:43008
    ds_read_b64_tr_b16 v[110:111], v11 offset:44032
    s_waitcnt lgkmcnt(4)
    v_mfma_f32_32x32x16_bf16 v[64:79], v[96:99], a[176:179], v[64:79]
    ds_read_b64_tr_b16 v[112:113], v10 offset:45056
    ds_read_b64_tr_b16 v[114:115], v10 offset:46080
    v_mfma_f32_32x32x16_bf16 v[80:95], v[100:103], a[176:179], v[80:95]
    ds_read_b64_tr_b16 v[116:117], v11 offset:45056
    ds_read_b64_tr_b16 v[118:119], v11 offset:46080
    s_waitcnt lgkmcnt(4)
    v_mfma_f32_32x32x16_bf16 v[64:79], v[104:107], a[180:183], v[64:79]
    ds_read_b64_tr_b16 v[120:121], v10 offset:47104
    ds_read_b64_tr_b16 v[122:123], v10 offset:48128
    v_mfma_f32_32x32x16_bf16 v[80:95], v[108:111], a[180:183], v[80:95]
    ds_read_b64_tr_b16 v[124:125], v11 offset:47104
    ds_read_b64_tr_b16 v[126:127], v11 offset:48128
    s_waitcnt vmcnt(0)
    s_barrier
    s_waitcnt lgkmcnt(4)
    v_mfma_f32_32x32x16_bf16 v[64:79], v[112:115], a[184:187], v[64:79]
    ds_read_b64_tr_b16 v[96:97], v10 offset:49152
    ds_read_b64_tr_b16 v[98:99], v10 offset:50176
    v_mfma_f32_32x32x16_bf16 v[80:95], v[116:119], a[184:187], v[80:95]
    ds_read_b64_tr_b16 v[100:101], v11 offset:49152
    ds_read_b64_tr_b16 v[102:103], v11 offset:50176
    s_waitcnt lgkmcnt(4)
    v_mfma_f32_32x32x16_bf16 v[64:79], v[120:123], a[188:191], v[64:79]
    ds_read_b64_tr_b16 v[104:105], v10 offset:51200
    ds_read_b64_tr_b16 v[106:107], v10 offset:52224
    v_mfma_f32_32x32x16_bf16 v[80:95], v[124:127], a[188:191], v[80:95]
    ds_read_b64_tr_b16 v[108:109], v11 offset:51200
    ds_read_b64_tr_b16 v[110:111], v11 offset:52224
    s_waitcnt lgkmcnt(4)
    v_mfma_f32_32x32x16_bf16 v[64:79], v[96:99], a[192:195], v[64:79]
    ds_read_b64_tr_b16 v[112:113], v10 offset:53248
    ds_read_b64_tr_b16 v[114:115], v10 offset:54272
    v_mfma_f32_32x32x16_bf16 v[80:95], v[100:103], a[192:195], v[80:95]
    ds_read_b64_tr_b16 v[116:117], v11 offset:53248
    ds_read_b64_tr_b16 v[118:119], v11 offset:54272
    s_waitcnt lgkmcnt(4)
    v_mfma_f32_32x32x16_bf16 v[64:79], v[104:107], a[196:199], v[64:79]
    ds_read_b64_tr_b16 v[120:121], v10 offset:55296
    ds_read_b64_tr_b16 v[122:123], v10 offset:56320
    v_mfma_f32_32x32x16_bf16 v[80:95], v[108:111], a[196:199], v[80:95]
    ds_read_b64_tr_b16 v[124:125], v11 offset:55296
    ds_read_b64_tr_b16 v[126:127], v11 offset:56320
    s_waitcnt lgkmcnt(4)
    v_mfma_f32_32x32x16_bf16 v[64:79], v[112:115], a[200:203], v[64:79]
    ds_read_b64_tr_b16 v[96:97], v10 offset:57344
    ds_read_b64_tr_b16 v[98:99], v10 offset:58368
    v_mfma_f32_32x32x16_bf16 v[80:95], v[116:119], a[200:203], v[80:95]
    ds_read_b64_tr_b16 v[100:101], v11 offset:57344
    ds_read_b64_tr_b16 v[102:103], v11 offset:58368
    s_waitcnt lgkmcnt(4)
    v_mfma_f32_32x32x16_bf16 v[64:79], v[120:123], a[204:207], v[64:79]
    ds_read_b64_tr_b16 v[104:105], v10 offset:59392
    ds_read_b64_tr_b16 v[106:107], v10 offset:60416
    v_mfma_f32_32x32x16_bf16 v[80:95], v[124:127], a[204:207], v[80:95]
    ds_read_b64_tr_b16 v[108:109], v11 offset:59392
    ds_read_b64_tr_b16 v[110:111], v11 offset:60416
    s_waitcnt lgkmcnt(4)
    v_mfma_f32_32x32x16_bf16 v[64:79], v[96:99], a[208:211], v[64:79]
    ds_read_b64_tr_b16 v[112:113], v10 offset:61440
    ds_read_b64_tr_b16 v[114:115], v10 offset:62464
    v_mfma_f32_32x32x16_bf16 v[80:95], v[100:103], a[208:211], v[80:95]
    ds_read_b64_tr_b16 v[116:117], v11 offset:61440
    ds_read_b64_tr_b16 v[118:119], v11 offset:62464
    s_waitcnt lgkmcnt(4)
    v_mfma_f32_32x32x16_bf16 v[64:79], v[104:107], a[212:215], v[64:79]
    ds_read_b64_tr_b16 v[120:121], v10 offset:63488
    ds_read_b64_tr_b16 v[122:123], v10 offset:64512
    v_mfma_f32_32x32x16_bf16 v[80:95], v[108:111], a[212:215], v[80:95]
    ds_read_b64_tr_b16 v[124:125], v11 offset:63488
    ds_read_b64_tr_b16 v[126:127], v11 offset:64512
    s_waitcnt lgkmcnt(4)
    v_mfma_f32_32x32x16_bf16 v[64:79], v[112:115], a[216:219], v[64:79]
    v_mfma_f32_32x32x16_bf16 v[80:95], v[116:119], a[216:219], v[80:95]
    s_waitcnt lgkmcnt(0)
    v_mfma_f32_32x32x16_bf16 v[64:79], v[120:123], a[220:223], v[64:79]
    v_mfma_f32_32x32x16_bf16 v[80:95], v[124:127], a[220:223], v[80:95]
    s_add_u32 s35, s35, 1
    s_mov_b32 s68, s69
    s_add_u32 s69, s68, 128
L_fin:
    s_nop 15
    v_lshlrev_b32 v192, 16, v176
    v_and_b32 v193, s79, v176
    v_lshlrev_b32 v194, 16, v144
    v_and_b32 v195, s79, v144
    v_fma_f32 v194, v192, v64, v194
    v_fma_f32 v195, v193, v65, v195
    v_cvt_pk_bf16_f32 v144, v194, v195
    v_lshlrev_b32 v196, 16, v177
    v_and_b32 v197, s79, v177
    v_lshlrev_b32 v198, 16, v145
    v_and_b32 v199, s79, v145
    v_fma_f32 v198, v196, v66, v198
    v_fma_f32 v199, v197, v67, v199
    v_cvt_pk_bf16_f32 v145, v198, v199
    v_lshlrev_b32 v200, 16, v178
    v_and_b32 v201, s79, v178
    v_lshlrev_b32 v202, 16, v146
    v_and_b32 v203, s79, v146
    v_fma_f32 v202, v200, v68, v202
    v_fma_f32 v203, v201, v69, v203
    v_cvt_pk_bf16_f32 v146, v202, v203
    v_lshlrev_b32 v204, 16, v179
    v_and_b32 v205, s79, v179
    v_lshlrev_b32 v206, 16, v147
    v_and_b32 v207, s79, v147
    v_fma_f32 v206, v204, v70, v206
    v_fma_f32 v207, v205, v71, v207
    v_cvt_pk_bf16_f32 v147, v206, v207
    s_nop 1
    v_permlane32_swap_b32 v144, v146
    v_permlane32_swap_b32 v145, v147
    v_xor_b32 v20, 0, v234
    ds_write_b128 v20, v[144:147]
    v_lshlrev_b32 v192, 16, v180
    v_and_b32 v193, s79, v180
    v_lshlrev_b32 v194, 16, v148
    v_and_b32 v195, s79, v148
    v_fma_f32 v194, v192, v72, v194
    v_fma_f32 v195, v193, v73, v195
    v_cvt_pk_bf16_f32 v148, v194, v195
    v_lshlrev_b32 v196, 16, v181
    v_and_b32 v197, s79, v181
    v_lshlrev_b32 v198, 16, v149
    v_and_b32 v199, s79, v149
    v_fma_f32 v198, v196, v74, v198
    v_fma_f32 v199, v197, v75, v199
    v_cvt_pk_bf16_f32 v149, v198, v199
    v_lshlrev_b32 v200, 16, v182
    v_and_b32 v201, s79, v182
    v_lshlrev_b32 v202, 16, v150
    v_and_b32 v203, s79, v150
    v_fma_f32 v202, v200, v76, v202
    v_fma_f32 v203, v201, v77, v203
    v_cvt_pk_bf16_f32 v150, v202, v203
    v_lshlrev_b32 v204, 16, v183
    v_and_b32 v205, s79, v183
    v_lshlrev_b32 v206, 16, v151
    v_and_b32 v207, s79, v151
    v_fma_f32 v206, v204, v78, v206
    v_fma_f32 v207, v205, v79, v207
    v_cvt_pk_bf16_f32 v151, v206, v207
    s_nop 1
    v_permlane32_swap_b32 v148, v150
    v_permlane32_swap_b32 v149, v151
    v_xor_b32 v20, 32, v234
    ds_write_b128 v20, v[148:151]
    v_lshlrev_b32 v192, 16, v184
    v_and_b32 v193, s79, v184
    v_lshlrev_b32 v194, 16, v152
    v_and_b32 v195, s79, v152
    v_fma_f32 v194, v192, v80, v194
    v_fma_f32 v195, v193, v81, v195
    v_cvt_pk_bf16_f32 v152, v194, v195
    v_lshlrev_b32 v196, 16, v185
    v_and_b32 v197, s79, v185
    v_lshlrev_b32 v198, 16, v153
    v_and_b32 v199, s79, v153
    v_fma_f32 v198, v196, v82, v198
    v_fma_f32 v199, v197, v83, v199
    v_cvt_pk_bf16_f32 v153, v198, v199
    v_lshlrev_b32 v200, 16, v186
    v_and_b32 v201, s79, v186
    v_lshlrev_b32 v202, 16, v154
    v_and_b32 v203, s79, v154
    v_fma_f32 v202, v200, v84, v202
    v_fma_f32 v203, v201, v85, v203
    v_cvt_pk_bf16_f32 v154, v202, v203
    v_lshlrev_b32 v204, 16, v187
    v_and_b32 v205, s79, v187
    v_lshlrev_b32 v206, 16, v155
    v_and_b32 v207, s79, v155
    v_fma_f32 v206, v204, v86, v206
    v_fma_f32 v207, v205, v87, v207
    v_cvt_pk_bf16_f32 v155, v206, v207
    s_nop 1
    v_permlane32_swap_b32 v152, v154
    v_permlane32_swap_b32 v153, v155
    v_xor_b32 v20, 64, v234
    ds_write_b128 v20, v[152:155]
    v_lshlrev_b32 v192, 16, v188
    v_and_b32 v193, s79, v188
    v_lshlrev_b32 v194, 16, v156
    v_and_b32 v195, s79, v156
    v_fma_f32 v194, v192, v88, v194
    v_fma_f32 v195, v193, v89, v195
    v_cvt_pk_bf16_f32 v156, v194, v195
    v_lshlrev_b32 v196, 16, v189
    v_and_b32 v197, s79, v189
    v_lshlrev_b32 v198, 16, v157
    v_and_b32 v199, s79, v157
    v_fma_f32 v198, v196, v90, v198
    v_fma_f32 v199, v197, v91, v199
    v_cvt_pk_bf16_f32 v157, v198, v199
    v_lshlrev_b32 v200, 16, v190
    v_and_b32 v201, s79, v190
    v_lshlrev_b32 v202, 16, v158
    v_and_b32 v203, s79, v158
    v_fma_f32 v202, v200, v92, v202
    v_fma_f32 v203, v201, v93, v203
    v_cvt_pk_bf16_f32 v158, v202, v203
    v_lshlrev_b32 v204, 16, v191
    v_and_b32 v205, s79, v191
    v_lshlrev_b32 v206, 16, v159
    v_and_b32 v207, s79, v159
    v_fma_f32 v206, v204, v94, v206
    v_fma_f32 v207, v205, v95, v207
    v_cvt_pk_bf16_f32 v159, v206, v207
    s_nop 1
    v_permlane32_swap_b32 v156, v158
    v_permlane32_swap_b32 v157, v159
    v_xor_b32 v20, 96, v234
    ds_write_b128 v20, v[156:159]
    ds_read_b128 v[192:195], v240 offset:0
    ds_read_b128 v[196:199], v241 offset:1024
    ds_read_b128 v[200:203], v240 offset:2048
    ds_read_b128 v[204:207], v241 offset:3072
    s_waitcnt lgkmcnt(0)
    buffer_store_dwordx4 v[192:195], v13, s[20:23], s88 offen offset:128 sc0 sc1
    buffer_store_dwordx4 v[196:199], v13, s[20:23], s89 offen offset:128 sc0 sc1
    buffer_store_dwordx4 v[200:203], v13, s[20:23], s90 offen offset:128 sc0 sc1
    buffer_store_dwordx4 v[204:207], v13, s[20:23], s91 offen offset:128 sc0 sc1
L_end:
    s_endpgm
Lslow_9:
    s_mov_b32 s80, 0
Lrlp_2:
    s_sleep 1
    buffer_load_dword v17, v225, s[28:31], 0 offen sc1
    s_waitcnt vmcnt(0)
    v_readfirstlane_b32 s75, v17
    s_nop 1
    s_and_b32 s76, s75, 0x0f0f0f0f
    s_lshr_b32 s77, s75, 4
    s_and_b32 s77, s77, 0x0f0f0f0f
    s_add_u32 s76, s76, s77
    s_mul_i32 s76, s76, 0x01010101
    s_lshr_b32 s76, s76, 24
    s_lshl_b32 s77, s37, 2
    s_lshr_b32 s77, s75, s77
    s_and_b32 s77, s77, 15
    s_cmp_eq_u32 s77, 8
    s_cselect_b32 s36, 1, 0
    s_cmp_ge_u32 s76, 8
    s_cbranch_scc1 Lrok_1
    s_add_u32 s80, s80, 1
    s_cmp_lt_u32 s80, 30000
    s_cbranch_scc1 Lrlp_2
    s_mov_b32 s36, 0
    s_branch Lrok_1
Lslow_10:
    s_mov_b32 s80, 0
Lplp_4:
    s_load_dwordx8 s[40:47], s[50:51], s82 glc
    s_waitcnt lgkmcnt(0)
    s_min_u32 s40, s40, s41
    s_min_u32 s42, s42, s43
    s_min_u32 s44, s44, s45
    s_min_u32 s46, s46, s47
    s_min_u32 s40, s40, s42
    s_min_u32 s44, s44, s46
    s_min_u32 s40, s40, s44
    s_cmp_ge_u32 s40, s35
    s_cbranch_scc1 Lpok_3
    s_add_u32 s80, s80, 1
    s_add_u32 s87, s87, 1
    s_cmp_lt_u32 s80, 64
    s_cbranch_scc1 Lplp_4
Lplv_5:
    buffer_load_dword v17, v14, s[16:19], s82 offen sc1
    s_waitcnt vmcnt(0)
    v_cmp_le_u32 vcc, s35, v17
    s_cmp_eq_u64 vcc, exec
    s_cbranch_scc1 Lpok_3
    s_sleep 1
    s_add_u32 s80, s80, 1
    s_cmp_lt_u32 s80, 30000
    s_cbranch_scc1 Lplv_5
    s_branch Lpok_3
Lslow_11:
    s_mov_b32 s80, 0
Lplp_7:
    s_load_dwordx8 s[40:47], s[50:51], s82 glc
    s_waitcnt lgkmcnt(0)
    s_min_u32 s40, s40, s41
    s_min_u32 s42, s42, s43
    s_min_u32 s44, s44, s45
    s_min_u32 s46, s46, s47
    s_min_u32 s40, s40, s42
    s_min_u32 s44, s44, s46
    s_min_u32 s40, s40, s44
    s_cmp_ge_u32 s40, s35
    s_cbranch_scc1 Lpok_6
    s_add_u32 s80, s80, 1
    s_add_u32 s87, s87, 1
    s_cmp_lt_u32 s80, 64
    s_cbranch_scc1 Lplp_7
Lplv_8:
    buffer_load_dword v17, v14, s[16:19], s82 offen sc1
    s_waitcnt vmcnt(0)
    v_cmp_le_u32 vcc, s35, v17
    s_cmp_eq_u64 vcc, exec
    s_cbranch_scc1 Lpok_6
    s_sleep 1
    s_add_u32 s80, s80, 1
    s_cmp_lt_u32 s80, 30000
    s_cbranch_scc1 Lplv_8
    s_branch Lpok_6
CODE_END:
.section .rodata,"a"
.p2align 6
.amdhsa_kernel standalone__dcn_v2_cross__recsys_kernel
  .amdhsa_next_free_vgpr 480
  .amdhsa_next_free_sgpr 102
  .amdhsa_accum_offset 256
  .amdhsa_group_segment_fixed_size 0
  .amdhsa_kernarg_size 48
  .amdhsa_user_sgpr_count 2
  .amdhsa_user_sgpr_kernarg_segment_ptr 1
  .amdhsa_system_sgpr_workgroup_id_x 1
.end_amdhsa_kernel
```
